```python
import torch

def _softmax(x, axis=-1):
    return torch.softmax(x, dim=axis)
def _gelu(x):
    return torch.nn.functional.gelu(x, approximate="tanh")
def _silu(x):
    return torch.nn.functional.silu(x)
def _sigmoid(x):
    return torch.sigmoid(x)
def _layernorm(x, axis=-1, eps=1e-5):
    m = x.mean(dim=axis, keepdim=True)
    v = x.var(dim=axis, keepdim=True, unbiased=False)
    return (x - m) / torch.sqrt(v + eps)
def _scatter_add(tgt, idx, src, axis=0):
    return tgt.clone().index_add_(axis, idx, src)
def _segment_sum(src, seg, n):
    out = torch.zeros((n,) + src.shape[1:], dtype=src.dtype)
    return out.index_add_(0, seg, src)
def _pad(x, pw):
    flat = tuple(v for pair in reversed(pw) for v in pair)
    return torch.nn.functional.pad(x, flat)

kernel_name = 'parallel_sum__sliding_block_cached__dense_activation_silu__decode'

def setup_inputs():

    _w = (lambda a: (lambda t: t.to(torch.bfloat16) if t.is_floating_point() else t)(torch.as_tensor(a)))
    def _A_setup():
        B, Sq, D = 4, 1, 512
        Hq, Hkv, Sk, Dh = 32, 32, 8192, 128
        assert Hq % Hkv == 0, (Hq, Hkv)
        return {
            "x": _w((lambda *s: torch.randn(*s, dtype=torch.bfloat16) * 0.05)(B, Sq, D)),
            "k_cache": _w((lambda *s: torch.randn(*s, dtype=torch.bfloat16) * 3.2)(B, Hkv, Sk, Dh)),
            "v_cache": _w((lambda *s: torch.randn(*s, dtype=torch.bfloat16) * 0.8)(B, Hkv, Sk, Dh)),
            "wq": _w((lambda *s: torch.randn(*s, dtype=torch.bfloat16) * 3.2)(D, Hq * Dh) * (D ** -0.5)),
            "wo": _w((lambda *s: torch.randn(*s, dtype=torch.bfloat16) * 0.8)(Hq * Dh, D) * ((Hq * Dh) ** -0.5)),
        }
    _A_in = _A_setup()

    def _B_setup():
        B, S, D, F = 4, 1, 512, 1376
        return {
            "x": _w((lambda *s: torch.randn(*s, dtype=torch.bfloat16) * 0.05)(B, S, D)),
            "w1": _w((lambda *s: torch.randn(*s, dtype=torch.bfloat16) * 3.2)(D, F) * (D ** -0.5)),
            "w2": _w((lambda *s: torch.randn(*s, dtype=torch.bfloat16) * 0.4)(F, D) * (F ** -0.5)),
        }
    _B_in = _B_setup()

    return {
        "A_x": _A_in["x"],
        "A_k_cache": _A_in["k_cache"],
        "A_v_cache": _A_in["v_cache"],
        "A_wq": _A_in["wq"],
        "A_wo": _A_in["wo"],
        "B_x": _B_in["x"],
        "B_w1": _B_in["w1"],
        "B_w2": _B_in["w2"],
    }

def reference(A_x, A_k_cache, A_v_cache, A_wq, A_wo, B_x, B_w1, B_w2):
    def _A_ref(x, k_cache, v_cache, wq, wo):
        B, Sq, D = x.shape
        Hq, Dh = 32, 128
        Hkv, Sk = k_cache.shape[1], k_cache.shape[2]
        W = min(4096, max(256, Sk // 4))
        rep = Hq // Hkv
        q = (lambda x, *d: x.permute(*d))((x @ wq).reshape(B, Sq, Hq, Dh), 0, 2, 1, 3)
        k = (lambda x, n, axis: torch.repeat_interleave(x, n, dim=axis))(k_cache[:, :, Sk - W:, :], rep, axis=1)
        v = (lambda x, n, axis: torch.repeat_interleave(x, n, dim=axis))(v_cache[:, :, Sk - W:, :], rep, axis=1)
        scores = torch.einsum("bhqd,bhkd->bhqk", q, k) * (Dh ** -0.5)
        p = _softmax(scores, axis=-1)
        o = torch.einsum("bhqk,bhkd->bhqd", p, v)
        return (lambda x, *d: x.permute(*d))(o, 0, 2, 1, 3).reshape(B, Sq, Hq * Dh) @ wo

    def _B_ref(x, w1, w2):
        h = torch.einsum("bsd,df->bsf", x, w1)
        h = _silu(h)
        out = torch.einsum("bsf,fd->bsd", h, w2)
        return out

    x = A_x
    xn = _layernorm(x, axis=-1)
    return x + _A_ref(xn, A_k_cache, A_v_cache, A_wq, A_wo) + _B_ref(xn, B_w1, B_w2)
```

```asm
; @launch grid=(256,1,1) block=(512,1,1) lds=74240
.amdgcn_target "amdgcn-amd-amdhsa--gfx950"
.text
.globl parallel_sum__sliding_block_cached__dense_activation_silu__decode_kernel
.p2align 8
.type parallel_sum__sliding_block_cached__dense_activation_silu__decode_kernel,@function
parallel_sum__sliding_block_cached__dense_activation_silu__decode_kernel:
  s_cmp_ge_u32 s2, 256
  s_cbranch_scc1 L_main_end
  s_load_dwordx16 s[4:19], s[0:1], 0
  s_load_dwordx4 s[20:23], s[0:1], 64
  s_load_dwordx2 s[24:25], s[0:1], 80
  s_and_b32 s65, s2, 7
  s_lshr_b32 s66, s2, 3
  s_lshr_b32 s67, s66, 3
  s_lshl_b32 s68, s65, 2
  s_add_u32 s61, s67, s68
  s_and_b32 s3, s66, 7
  s_lshr_b32 s60, s3, 1
  s_and_b32 s62, s66, 1
  s_lshl_b32 s63, s61, 1
  s_add_u32 s63, s63, s62
  s_lshl_b32 s65, s60, 5
  s_add_u32 s65, s65, s61
  s_lshl_b32 s65, s65, 21
  s_lshl_b32 s66, s62, 18
  s_add_u32 s65, s65, s66
  s_add_u32 s26, s65, 1572864
  s_mov_b32 s84, 0
  s_mov_b32 s85, 0
  v_and_b32 v1, 63, v0
  v_lshrrev_b32 v7, 6, v0
  v_lshlrev_b32 v8, 4, v1
  v_readfirstlane_b32 s64, v7
  v_lshl_add_u32 v2, v7, 10, v8
  v_lshrrev_b32 v9, 4, v1
  v_and_b32 v10, 15, v1
  s_lshl_b32 s65, s3, 6
  v_lshlrev_b32 v13, 3, v7
  v_add_u32 v13, s65, v13
  v_add_u32 v11, v13, v9
  v_lshlrev_b32 v11, 13, v11
  v_lshl_add_u32 v3, v10, 4, v11
  v_add_u32 v11, v13, v9
  v_mul_u32_u24 v11, 2752, v11
  v_lshl_add_u32 v4, v10, 4, v11
  v_mov_b32 v13, 0
  s_waitcnt lgkmcnt(0)
  s_add_u32 s28, s6, s26
  s_addc_u32 s29, s7, 0
  s_and_b32 s29, s29, 0xffff
  s_mov_b32 s30, 262144
  s_mov_b32 s31, 0x20000
  buffer_load_dwordx4 v[80:83], v2, s[28:31], s84 offen nt
  s_add_u32 s84, s84, 8192
  buffer_load_dwordx4 v[84:87], v2, s[28:31], s84 offen nt
  s_add_u32 s84, s84, 8192
  s_or_b32 s65, s2, s64
  s_cmp_lg_u32 s65, 0
  s_cbranch_scc1 L_noep
  s_memrealtime s[90:91]
  s_waitcnt lgkmcnt(0)
  s_or_b32 s90, s90, 1
  v_mov_b32 v12, s90
  global_store_dword v13, v12, s[22:23] sc0 sc1
L_noep:
  s_mov_b32 s52, s4
  s_and_b32 s53, s5, 0xffff
  s_mov_b32 s54, 4096
  s_mov_b32 s55, 0x20000
  s_cmp_ge_u32 s64, 4
  s_cbranch_scc1 L_nox
  s_lshl_b32 s65, s64, 10
  buffer_load_dwordx4 v[48:51], v8, s[52:55], s65 offen
L_nox:
  s_lshl_b32 s65, s61, 8
  s_sub_u32 s66, 4194304, s65
  s_add_u32 s36, s10, s65
  s_addc_u32 s37, s11, 0
  s_and_b32 s37, s37, 0xffff
  s_mov_b32 s38, s66
  s_mov_b32 s39, 0x20000
  buffer_load_dwordx4 v[240:243], v3, s[36:39], 0 offen nt
  s_mov_b32 s65, 32768
  buffer_load_dwordx4 v[244:247], v3, s[36:39], s65 offen nt
  s_mul_i32 s65, s61, 96
  s_sub_u32 s66, 1409024, s65
  s_cmp_lt_u32 s61, 29
  s_cselect_b32 s66, s66, 0
  s_cselect_b32 s65, s65, 0
  s_add_u32 s40, s16, s65
  s_addc_u32 s41, s17, 0
  s_and_b32 s41, s41, 0xffff
  s_mov_b32 s42, s66
  s_mov_b32 s43, 0x20000
  s_mov_b32 exec_lo, 0x003f003f
  s_mov_b32 exec_hi, 0x003f003f
  buffer_load_dwordx4 v[248:251], v4, s[40:43], 0 offen nt
  s_mov_b32 s65, 11008
  buffer_load_dwordx4 v[252:255], v4, s[40:43], s65 offen nt
  s_mov_b64 exec, -1
  buffer_load_dwordx4 v[88:91], v2, s[28:31], s84 offen nt
  s_add_u32 s84, s84, 8192
  buffer_load_dwordx4 v[92:95], v2, s[28:31], s84 offen nt
  s_add_u32 s84, s84, 8192
  buffer_load_dwordx4 v[96:99], v2, s[28:31], s84 offen nt
  s_add_u32 s84, s84, 8192
  s_mov_b32 s80, 0
  s_mov_b32 s81, 8192
  s_mov_b32 s82, 16384
  s_mov_b32 s83, 0
  v_and_b32 v11, 1, v1
  v_cmp_ne_u32 s[70:71], 0, v11
  v_and_b32 v11, 2, v1
  v_cmp_ne_u32 s[72:73], 0, v11
  v_lshrrev_b32 v11, 3, v1
  v_lshlrev_b32 v11, 10, v11
  v_lshl_add_u32 v11, v7, 7, v11
  v_and_b32 v12, 7, v1
  v_lshl_add_u32 v6, v12, 4, v11
  v_lshrrev_b32 v11, 2, v10
  v_lshl_add_u32 v11, v9, 3, v11
  v_mul_u32_u24 v11, 144, v11
  v_and_b32 v12, 3, v10
  v_lshl_add_u32 v11, v12, 3, v11
  v_mul_u32_u24 v12, 4608, v7
  v_add_u32 v11, v11, v12
  v_add_u32 v5, 37376, v11
  s_add_u32 s32, s8, s26
  s_addc_u32 s33, s9, 0
  s_and_b32 s33, s33, 0xffff
  s_mov_b32 s34, 262144
  s_mov_b32 s35, 0x20000
  s_mul_i32 s65, s63, 24576
  s_sub_u32 s66, 1409024, s65
  s_cmp_lt_u32 s63, 58
  s_cselect_b32 s66, s66, 0
  s_cselect_b32 s65, s65, 0
  s_add_u32 s44, s18, s65
  s_addc_u32 s45, s19, 0
  s_and_b32 s45, s45, 0xffff
  s_mov_b32 s46, s66
  s_mov_b32 s47, 0x20000
  s_lshl_b32 s65, s61, 17
  s_add_u32 s48, s12, s65
  s_addc_u32 s49, s13, 0
  s_and_b32 s49, s49, 0xffff
  s_mov_b32 s50, 131072
  s_mov_b32 s51, 0x20000
  s_mov_b32 s56, s24
  s_and_b32 s57, s25, 0xffff
  s_mov_b32 s58, 2097152
  s_mov_b32 s59, 0x20000
  s_mov_b32 s92, 117835008
  s_mov_b32 s93, 117835009
  s_mov_b32 s94, 117835010
  s_mov_b32 s95, 117835011
  s_mov_b32 s96, 0x0c0c0400
  s_mov_b32 s97, 0x04000c0c
  v_lshlrev_b32 v15, 3, v10
  v_mov_b32 v16, 0xff800000
  v_mov_b32 v17, 0
  ds_write_b64 v15, v[16:17] offset:4352
  ds_write_b32 v15, v17 offset:4480
  v_mov_b32 v24, 0
  v_mov_b32 v25, 0
  v_mov_b32 v26, 0
  v_mov_b32 v27, 0
  v_lshlrev_b32 v11, 4, v0
  ds_write_b128 v11, v[24:27] offset:4608
  s_cmp_ge_u32 s64, 4
  s_cbranch_scc1 L_noln
  s_waitcnt vmcnt(7)
  v_lshlrev_b32 v52, 16, v48
  v_and_b32 v53, 0xffff0000, v48
  v_lshlrev_b32 v54, 16, v49
  v_and_b32 v55, 0xffff0000, v49
  v_lshlrev_b32 v56, 16, v50
  v_and_b32 v57, 0xffff0000, v50
  v_lshlrev_b32 v58, 16, v51
  v_and_b32 v59, 0xffff0000, v51
  v_add_f32 v60, v52, v53
  v_add_f32 v60, v60, v54
  v_add_f32 v60, v60, v55
  v_add_f32 v60, v60, v56
  v_add_f32 v60, v60, v57
  v_add_f32 v60, v60, v58
  v_add_f32 v60, v60, v59
s_nop 1
  v_add_f32_dpp v60, v60, v60 quad_perm:[1,0,3,2] row_mask:0xf bank_mask:0xf
s_nop 1
  v_add_f32_dpp v60, v60, v60 quad_perm:[2,3,0,1] row_mask:0xf bank_mask:0xf
s_nop 1
  v_add_f32_dpp v60, v60, v60 row_half_mirror row_mask:0xf bank_mask:0xf
s_nop 1
  v_add_f32_dpp v60, v60, v60 row_mirror row_mask:0xf bank_mask:0xf
s_nop 1
  v_add_f32_dpp v60, v60, v60 row_bcast:15 row_mask:0xa bank_mask:0xf
s_nop 1
  v_add_f32_dpp v60, v60, v60 row_bcast:31 row_mask:0xc bank_mask:0xf
s_nop 0
  v_readlane_b32 s65, v60, 63
s_nop 1
  v_mov_b32 v61, s65
  v_mul_f32 v61, 0x3b000000, v61
  v_sub_f32 v62, v52, v61
  v_mul_f32 v60, v62, v62
  v_sub_f32 v62, v53, v61
  v_fmac_f32 v60, v62, v62
  v_sub_f32 v62, v54, v61
  v_fmac_f32 v60, v62, v62
  v_sub_f32 v62, v55, v61
  v_fmac_f32 v60, v62, v62
  v_sub_f32 v62, v56, v61
  v_fmac_f32 v60, v62, v62
  v_sub_f32 v62, v57, v61
  v_fmac_f32 v60, v62, v62
  v_sub_f32 v62, v58, v61
  v_fmac_f32 v60, v62, v62
  v_sub_f32 v62, v59, v61
  v_fmac_f32 v60, v62, v62
s_nop 1
  v_add_f32_dpp v60, v60, v60 quad_perm:[1,0,3,2] row_mask:0xf bank_mask:0xf
s_nop 1
  v_add_f32_dpp v60, v60, v60 quad_perm:[2,3,0,1] row_mask:0xf bank_mask:0xf
s_nop 1
  v_add_f32_dpp v60, v60, v60 row_half_mirror row_mask:0xf bank_mask:0xf
s_nop 1
  v_add_f32_dpp v60, v60, v60 row_mirror row_mask:0xf bank_mask:0xf
s_nop 1
  v_add_f32_dpp v60, v60, v60 row_bcast:15 row_mask:0xa bank_mask:0xf
s_nop 1
  v_add_f32_dpp v60, v60, v60 row_bcast:31 row_mask:0xc bank_mask:0xf
s_nop 0
  v_readlane_b32 s65, v60, 63
s_nop 1
  v_mov_b32 v62, s65
  v_mul_f32 v62, 0x3b000000, v62
  v_cvt_pk_bf16_f32 v61, v61, v61
  v_lshlrev_b32 v61, 16, v61
  v_cvt_pk_bf16_f32 v62, v62, v62
  v_lshlrev_b32 v62, 16, v62
  v_add_f32 v62, 0x3727c5ac, v62
  v_cvt_pk_bf16_f32 v62, v62, v62
  v_lshlrev_b32 v62, 16, v62
  v_sqrt_f32 v62, v62
s_nop 0
  v_cvt_pk_bf16_f32 v62, v62, v62
  v_lshlrev_b32 v62, 16, v62
  v_rcp_f32 v63, v62
  v_sub_f32 v52, v52, v61
  v_sub_f32 v53, v53, v61
  v_sub_f32 v54, v54, v61
  v_sub_f32 v55, v55, v61
  v_sub_f32 v56, v56, v61
  v_sub_f32 v57, v57, v61
  v_sub_f32 v58, v58, v61
  v_sub_f32 v59, v59, v61
  v_cvt_pk_bf16_f32 v48, v52, v53
  v_cvt_pk_bf16_f32 v49, v54, v55
  v_cvt_pk_bf16_f32 v50, v56, v57
  v_cvt_pk_bf16_f32 v51, v58, v59
  v_lshlrev_b32 v52, 16, v48
  v_and_b32 v53, 0xffff0000, v48
  v_lshlrev_b32 v54, 16, v49
  v_and_b32 v55, 0xffff0000, v49
  v_lshlrev_b32 v56, 16, v50
  v_and_b32 v57, 0xffff0000, v50
  v_lshlrev_b32 v58, 16, v51
  v_and_b32 v59, 0xffff0000, v51
  v_mul_f32 v208, v52, v63
  v_mul_f32 v209, v53, v63
  v_mul_f32 v210, v54, v63
  v_mul_f32 v211, v55, v63
  v_mul_f32 v212, v56, v63
  v_mul_f32 v213, v57, v63
  v_mul_f32 v214, v58, v63
  v_mul_f32 v215, v59, v63
  v_fma_f32 v52, -v208, v62, v52
  v_fma_f32 v53, -v209, v62, v53
  v_fma_f32 v54, -v210, v62, v54
  v_fma_f32 v55, -v211, v62, v55
  v_fma_f32 v56, -v212, v62, v56
  v_fma_f32 v57, -v213, v62, v57
  v_fma_f32 v58, -v214, v62, v58
  v_fma_f32 v59, -v215, v62, v59
  v_fmac_f32 v208, v52, v63
  v_fmac_f32 v209, v53, v63
  v_fmac_f32 v210, v54, v63
  v_fmac_f32 v211, v55, v63
  v_fmac_f32 v212, v56, v63
  v_fmac_f32 v213, v57, v63
  v_fmac_f32 v214, v58, v63
  v_fmac_f32 v215, v59, v63
  v_cvt_pk_bf16_f32 v48, v208, v209
  v_cvt_pk_bf16_f32 v49, v210, v211
  v_cvt_pk_bf16_f32 v50, v212, v213
  v_cvt_pk_bf16_f32 v51, v214, v215
  v_lshl_add_u32 v11, v7, 10, v8
  ds_write_b128 v11, v[48:51] offset:0
L_noln:
  s_lshl_b32 s65, s3, 6
  v_lshlrev_b32 v13, 3, v7
  v_add_u32 v13, s65, v13
  v_add_u32 v11, v13, v9
  v_lshlrev_b32 v11, 1, v11
  v_lshrrev_b32 v12, 3, v10
  v_lshl_add_u32 v11, v12, 10, v11
  v_and_b32 v12, 1, v10
  v_lshlrev_b32 v12, 4, v12
  s_mov_b32 s65, 0xffff
  v_mov_b32 v228, 0xffff
  v_lshlrev_b32 v12, v12, v228
  v_bfe_u32 v228, v10, 1, 2
  v_cmp_eq_u32 vcc, 0, v228
s_nop 1
  v_cndmask_b32 v224, 0, v12, vcc
  v_cmp_eq_u32 vcc, 1, v228
s_nop 1
  v_cndmask_b32 v225, 0, v12, vcc
  v_cmp_eq_u32 vcc, 2, v228
s_nop 1
  v_cndmask_b32 v226, 0, v12, vcc
  v_cmp_eq_u32 vcc, 3, v228
s_nop 1
  v_cndmask_b32 v227, 0, v12, vcc
  v_mov_b32 v13, 0
  s_waitcnt lgkmcnt(0)
  s_barrier
  ds_read_u16 v48, v11 offset:0
  ds_read_u16 v49, v11 offset:2048
  ds_read_u16 v50, v11 offset:8
  ds_read_u16 v51, v11 offset:2056
  s_cmp_lg_u32 s64, 3
  s_cbranch_scc1 L_skip1
  global_load_dword v47, v13, s[22:23] sc1
L_skip1:
  s_cmp_lg_u32 s64, 0
  s_cbranch_scc1 L_skip2
  v_and_b32 v11, 1, v10
  v_lshl_add_u32 v11, v11, 2, v9
  s_lshl_b32 s65, s63, 3
  s_lshl_b32 s66, s60, 9
  s_add_u32 s65, s65, s66
  v_add_u32 v11, s65, v11
  v_lshlrev_b32 v11, 1, v11
  buffer_load_ushort v46, v11, s[52:55], 0 offen
L_skip2:
  buffer_load_dwordx4 v[100:103], v2, s[28:31], s84 offen nt
  s_add_u32 s84, s84, 8192
  buffer_load_dwordx4 v[104:107], v2, s[28:31], s84 offen nt
  s_add_u32 s84, s84, 8192
  buffer_load_dwordx4 v[108:111], v2, s[28:31], s84 offen nt
  s_add_u32 s84, s84, 8192
  buffer_load_dwordx4 v[112:115], v2, s[28:31], s84 offen nt
  s_add_u32 s84, s84, 8192
  buffer_load_dwordx4 v[116:119], v2, s[28:31], s84 offen nt
  s_add_u32 s84, s84, 8192
  buffer_load_dwordx4 v[120:123], v2, s[28:31], s84 offen nt
  s_add_u32 s84, s84, 8192
  s_waitcnt lgkmcnt(0)
  v_lshl_or_b32 v48, v48, 16, v48
  v_lshl_or_b32 v49, v49, 16, v49
  v_lshl_or_b32 v50, v50, 16, v50
  v_lshl_or_b32 v51, v51, 16, v51
  v_and_b32 v208, v48, v224
  v_and_b32 v209, v48, v225
  v_and_b32 v210, v48, v226
  v_and_b32 v211, v48, v227
  v_and_b32 v212, v49, v224
  v_and_b32 v213, v49, v225
  v_and_b32 v214, v49, v226
  v_and_b32 v215, v49, v227
  v_and_b32 v216, v50, v224
  v_and_b32 v217, v50, v225
  v_and_b32 v218, v50, v226
  v_and_b32 v219, v50, v227
  v_and_b32 v220, v51, v224
  v_and_b32 v221, v51, v225
  v_and_b32 v222, v51, v226
  v_and_b32 v223, v51, v227
  s_waitcnt vmcnt(11)
  v_mfma_f32_16x16x32_bf16 v[16:19], v[208:211], v[240:243], 0
  v_mfma_f32_16x16x32_bf16 v[20:23], v[212:215], v[240:243], 0
  v_mfma_f32_16x16x32_bf16 v[16:19], v[216:219], v[244:247], v[16:19]
  v_mfma_f32_16x16x32_bf16 v[20:23], v[220:223], v[244:247], v[20:23]
  s_waitcnt vmcnt(9)
  v_mfma_f32_16x16x32_bf16 v[24:27], v[208:211], v[248:251], 0
  v_mfma_f32_16x16x32_bf16 v[28:31], v[212:215], v[248:251], 0
  v_mfma_f32_16x16x32_bf16 v[24:27], v[216:219], v[252:255], v[24:27]
  v_mfma_f32_16x16x32_bf16 v[28:31], v[220:223], v[252:255], v[28:31]
  buffer_load_dwordx4 v[124:127], v2, s[28:31], s84 offen nt
  s_add_u32 s84, s84, 8192
  buffer_load_dwordx4 v[128:131], v2, s[28:31], s84 offen nt
  s_add_u32 s84, s84, 8192
  v_and_b32 v11, 1, v9
  v_lshlrev_b32 v11, 4, v11
  v_lshl_add_u32 v11, v10, 5, v11
  v_lshrrev_b32 v12, 1, v9
  v_lshl_add_u32 v13, v12, 9, v11
  v_lshl_add_u32 v13, v7, 11, v13
  v_lshl_add_u32 v12, v12, 8, v11
  v_lshl_add_u32 v12, v7, 10, v12
  ds_write_b128 v13, v[16:19] offset:20992
  ds_write_b128 v13, v[20:23] offset:22016
  s_mov_b32 exec_lo, 0x003f003f
  s_mov_b32 exec_hi, 0x003f003f
  ds_write_b128 v12, v[24:27] offset:12800
  ds_write_b128 v12, v[28:31] offset:13312
  s_mov_b64 exec, -1
  v_lshl_add_u32 v14, v10, 2, v9
  v_lshlrev_b32 v14, 2, v14
  v_mul_u32_u24 v12, 272, v7
  v_add_u32 v14, v14, v12
  v_lshrrev_b32 v12, 3, v1
  v_mul_u32_u24 v12, 144, v12
  v_and_b32 v13, 7, v1
  v_lshl_add_u32 v12, v13, 4, v12
  v_mul_u32_u24 v13, 4608, v7
  v_add_u32 v12, v12, v13
  v_add_u32 v4, 37376, v12
  v_mov_b32 v13, 0
  buffer_load_dwordx4 v[132:135], v2, s[28:31], s84 offen nt
  s_add_u32 s84, s84, 8192
  s_waitcnt lgkmcnt(0)
  s_barrier
  buffer_load_dwordx4 v[136:139], v2, s[28:31], s84 offen nt
  s_add_u32 s84, s84, 8192
  s_cmp_lg_u32 s64, 3
  s_cbranch_scc1 L_skip3
  s_setprio 3
  s_waitcnt vmcnt(10)
  v_readfirstlane_b32 s27, v47
s_nop 3
  s_cmp_lg_u32 s27, 0
  s_cbranch_scc1 L_ep_ok
  s_mov_b32 s65, 0
L_ep_loop:
  global_load_dword v47, v13, s[22:23] sc1
  s_waitcnt vmcnt(0)
  v_readfirstlane_b32 s27, v47
  s_add_u32 s65, s65, 1
  s_cmp_ge_u32 s65, 200000
  s_cbranch_scc1 L_ep_ok
s_nop 0
  s_cmp_eq_u32 s27, 0
  s_cbranch_scc1 L_ep_loop
L_ep_ok:
  ds_write_b32 v13, v47 offset:4504
  ds_read_b128 v[208:211], v8 offset:20992
  ds_read_b128 v[212:215], v8 offset:23040
  ds_read_b128 v[216:219], v8 offset:25088
  ds_read_b128 v[220:223], v8 offset:27136
  ds_read_b128 v[224:227], v8 offset:29184
  ds_read_b128 v[228:231], v8 offset:31232
  ds_read_b128 v[232:235], v8 offset:33280
  ds_read_b128 v[236:239], v8 offset:35328
  v_lshrrev_b32 v11, 5, v1
  v_lshlrev_b32 v11, 12, v11
  v_and_b32 v12, 31, v1
  v_lshl_add_u32 v11, v12, 4, v11
  s_lshl_b32 s65, s61, 14
  s_lshl_b32 s66, s3, 9
  s_add_u32 s65, s65, s66
  s_add_u32 s65, s65, 589824
  s_waitcnt lgkmcnt(0)
  v_pk_add_f32 v[208:209], v[208:209], v[212:213]
  v_pk_add_f32 v[210:211], v[210:211], v[214:215]
  v_pk_add_f32 v[216:217], v[216:217], v[220:221]
  v_pk_add_f32 v[218:219], v[218:219], v[222:223]
  v_pk_add_f32 v[224:225], v[224:225], v[228:229]
  v_pk_add_f32 v[226:227], v[226:227], v[230:231]
  v_pk_add_f32 v[232:233], v[232:233], v[236:237]
  v_pk_add_f32 v[234:235], v[234:235], v[238:239]
  v_pk_add_f32 v[208:209], v[208:209], v[216:217]
  v_pk_add_f32 v[210:211], v[210:211], v[218:219]
  v_pk_add_f32 v[224:225], v[224:225], v[232:233]
  v_pk_add_f32 v[226:227], v[226:227], v[234:235]
  v_pk_add_f32 v[208:209], v[208:209], v[224:225]
  v_pk_add_f32 v[210:211], v[210:211], v[226:227]
  v_perm_b32 v48, v208, v47, s92
  v_perm_b32 v49, v209, v47, s93
  v_perm_b32 v50, v210, v47, s94
  v_perm_b32 v51, v211, v47, s95
  buffer_store_dwordx4 v[48:51], v11, s[56:59], s65 offen offset:0 sc1
  s_add_u32 s66, s65, 8192
  ds_read_b128 v[208:211], v8 offset:22016
  ds_read_b128 v[212:215], v8 offset:24064
  ds_read_b128 v[216:219], v8 offset:26112
  ds_read_b128 v[220:223], v8 offset:28160
  ds_read_b128 v[224:227], v8 offset:30208
  ds_read_b128 v[228:231], v8 offset:32256
  ds_read_b128 v[232:235], v8 offset:34304
  ds_read_b128 v[236:239], v8 offset:36352
  s_waitcnt lgkmcnt(0)
  v_pk_add_f32 v[208:209], v[208:209], v[212:213]
  v_pk_add_f32 v[210:211], v[210:211], v[214:215]
  v_pk_add_f32 v[216:217], v[216:217], v[220:221]
  v_pk_add_f32 v[218:219], v[218:219], v[222:223]
  v_pk_add_f32 v[224:225], v[224:225], v[228:229]
  v_pk_add_f32 v[226:227], v[226:227], v[230:231]
  v_pk_add_f32 v[232:233], v[232:233], v[236:237]
  v_pk_add_f32 v[234:235], v[234:235], v[238:239]
  v_pk_add_f32 v[208:209], v[208:209], v[216:217]
  v_pk_add_f32 v[210:211], v[210:211], v[218:219]
  v_pk_add_f32 v[224:225], v[224:225], v[232:233]
  v_pk_add_f32 v[226:227], v[226:227], v[234:235]
  v_pk_add_f32 v[208:209], v[208:209], v[224:225]
  v_pk_add_f32 v[210:211], v[210:211], v[226:227]
  v_perm_b32 v52, v208, v47, s92
  v_perm_b32 v53, v209, v47, s93
  v_perm_b32 v54, v210, v47, s94
  v_perm_b32 v55, v211, v47, s95
  buffer_store_dwordx4 v[52:55], v11, s[56:59], s66 offen sc1
  ds_read_b128 v[208:211], v8 offset:12800
  ds_read_b128 v[212:215], v8 offset:13824
  ds_read_b128 v[216:219], v8 offset:14848
  ds_read_b128 v[220:223], v8 offset:15872
  ds_read_b128 v[224:227], v8 offset:16896
  ds_read_b128 v[228:231], v8 offset:17920
  ds_read_b128 v[232:235], v8 offset:18944
  ds_read_b128 v[236:239], v8 offset:19968
  v_cmp_le_u32 vcc, 6, v10
s_nop 1
  v_cndmask_b32 v11, 0, 1, vcc
  v_mul_u32_u24 v12, 6, v11
  v_sub_u32 v12, v10, v12
  v_lshlrev_b32 v12, 4, v12
  v_lshl_add_u32 v12, v11, 10, v12
  v_lshl_add_u32 v12, v9, 11, v12
  s_lshl_b32 s65, s61, 13
  s_lshl_b32 s66, s3, 7
  s_add_u32 s65, s65, s66
  s_add_u32 s65, s65, 1114112
  s_waitcnt lgkmcnt(0)
  v_pk_add_f32 v[208:209], v[208:209], v[212:213]
  v_pk_add_f32 v[210:211], v[210:211], v[214:215]
  v_pk_add_f32 v[216:217], v[216:217], v[220:221]
  v_pk_add_f32 v[218:219], v[218:219], v[222:223]
  v_pk_add_f32 v[224:225], v[224:225], v[228:229]
  v_pk_add_f32 v[226:227], v[226:227], v[230:231]
  v_pk_add_f32 v[232:233], v[232:233], v[236:237]
  v_pk_add_f32 v[234:235], v[234:235], v[238:239]
  v_pk_add_f32 v[208:209], v[208:209], v[216:217]
  v_pk_add_f32 v[210:211], v[210:211], v[218:219]
  v_pk_add_f32 v[224:225], v[224:225], v[232:233]
  v_pk_add_f32 v[226:227], v[226:227], v[234:235]
  v_pk_add_f32 v[208:209], v[208:209], v[224:225]
  v_pk_add_f32 v[210:211], v[210:211], v[226:227]
  v_perm_b32 v56, v208, v47, s92
  v_perm_b32 v57, v209, v47, s93
  v_perm_b32 v58, v210, v47, s94
  v_perm_b32 v59, v211, v47, s95
  s_mov_b32 exec_lo, 0x0fff0fff
  s_mov_b32 exec_hi, 0x0fff0fff
  buffer_store_dwordx4 v[56:59], v12, s[56:59], s65 offen sc1
  s_mov_b64 exec, -1
  s_setprio 0
L_skip3:
  buffer_load_dwordx4 v[140:143], v2, s[28:31], s84 offen nt
  s_add_u32 s84, s84, 8192
  buffer_load_dwordx4 v[144:147], v2, s[28:31], s84 offen nt
  s_add_u32 s84, s84, 8192
  s_waitcnt vmcnt(5)
  buffer_load_dwordx4 v[148:151], v2, s[28:31], s84 offen nt
  s_add_u32 s84, s84, 8192
  s_waitcnt vmcnt(5)
  buffer_load_dwordx4 v[64:67], v6, s[44:47], s80 offen nt
  s_waitcnt vmcnt(5)
  buffer_load_dwordx4 v[152:155], v2, s[28:31], s84 offen nt
  s_add_u32 s84, s84, 8192
  s_waitcnt vmcnt(5)
  buffer_load_dwordx4 v[156:159], v2, s[28:31], s84 offen nt
  s_add_u32 s84, s84, 8192
  s_waitcnt vmcnt(5)
  buffer_load_dwordx4 v[160:163], v2, s[28:31], s84 offen nt
  s_add_u32 s84, s84, 8192
  s_waitcnt vmcnt(5)
  buffer_load_dwordx4 v[68:71], v6, s[44:47], s81 offen nt
  s_waitcnt vmcnt(5)
  buffer_load_dwordx4 v[164:167], v2, s[28:31], s84 offen nt
  s_add_u32 s84, s84, 8192
  s_lshl_b32 s65, s61, 2
  s_add_u32 s65, s65, s60
  s_lshl_b32 s26, s65, 12
  s_add_u32 s26, s26, 589824
  s_lshl_b32 s87, s65, 1
  s_add_u32 s87, s87, s62
  s_lshl_b32 s87, s87, 10
  s_add_u32 s87, s87, 1114112
  s_cmp_lg_u32 s64, 1
  s_cbranch_scc1 L_skip4
  buffer_load_dwordx4 v[16:19], v8, s[56:59], s26 offen offset:0 sc1
  buffer_load_dwordx4 v[20:23], v8, s[56:59], s26 offen offset:1024 sc1
  buffer_load_dwordx4 v[24:27], v8, s[56:59], s26 offen offset:2048 sc1
  buffer_load_dwordx4 v[28:31], v8, s[56:59], s26 offen offset:3072 sc1
L_skip4:
  s_cmp_lg_u32 s64, 2
  s_cbranch_scc1 L_skip5
  buffer_load_dwordx4 v[16:19], v8, s[56:59], s87 offen sc1
L_skip5:
  s_waitcnt vmcnt(5)
  buffer_load_dwordx4 v[168:171], v2, s[28:31], s84 offen nt
  s_add_u32 s84, s84, 8192
  s_waitcnt vmcnt(5)
  buffer_load_dwordx4 v[172:175], v2, s[28:31], s84 offen nt
  s_add_u32 s84, s84, 8192
  s_waitcnt vmcnt(5)
  buffer_load_dwordx4 v[72:75], v6, s[44:47], s82 offen nt
  s_waitcnt vmcnt(5)
  buffer_load_dwordx4 v[176:179], v2, s[28:31], s84 offen nt
  s_add_u32 s84, s84, 8192
  s_waitcnt vmcnt(5)
  buffer_load_dwordx4 v[180:183], v2, s[28:31], s84 offen nt
  s_add_u32 s84, s84, 8192
  s_waitcnt vmcnt(5)
  buffer_load_dwordx4 v[184:187], v2, s[28:31], s84 offen nt
  s_add_u32 s84, s84, 8192
  s_waitcnt vmcnt(5)
  buffer_load_dwordx4 v[208:211], v6, s[48:51], s83 offen nt
  s_add_u32 s83, s83, 8192
  s_cmp_lg_u32 s64, 1
  s_cbranch_scc1 L_skip6
  v_mov_b32 v11, 0
  s_mov_b32 s65, 0
L_e1_loop:
  ds_read_b32 v47, v11 offset:4504
  s_waitcnt lgkmcnt(0)
  v_readfirstlane_b32 s27, v47
  s_add_u32 s65, s65, 1
  s_cmp_ge_u32 s65, 200000
  s_cbranch_scc1 L_e1_ok
s_nop 0
  s_cmp_eq_u32 s27, 0
  s_cbranch_scc1 L_e1_loop
L_e1_ok:
  s_waitcnt vmcnt(7)
  v_perm_b32 v48, v17, v16, s96
  v_perm_b32 v49, v19, v18, s97
  v_or_b32 v48, v48, v49
  v_perm_b32 v50, v21, v20, s96
  v_perm_b32 v51, v23, v22, s97
  v_or_b32 v50, v50, v51
  v_perm_b32 v52, v25, v24, s96
  v_perm_b32 v53, v27, v26, s97
  v_or_b32 v52, v52, v53
  v_perm_b32 v54, v29, v28, s96
  v_perm_b32 v55, v31, v30, s97
  v_or_b32 v54, v54, v55
  v_xor_b32 v48, v48, v47
  v_xor_b32 v50, v50, v47
  v_xor_b32 v52, v52, v47
  v_xor_b32 v54, v54, v47
  v_or3_b32 v48, v48, v50, v52
  v_or_b32 v48, v48, v54
  v_cmp_ne_u32 s[90:91], 0, v48
s_nop 3
  s_cmp_eq_u64 s[90:91], 0
  s_cbranch_scc1 L_gq_ok
  s_mov_b32 s65, 0
L_gq_loop:
  buffer_load_dwordx4 v[16:19], v8, s[56:59], s26 offen offset:0 sc1
  buffer_load_dwordx4 v[20:23], v8, s[56:59], s26 offen offset:1024 sc1
  buffer_load_dwordx4 v[24:27], v8, s[56:59], s26 offen offset:2048 sc1
  buffer_load_dwordx4 v[28:31], v8, s[56:59], s26 offen offset:3072 sc1
  s_waitcnt vmcnt(0)
  v_perm_b32 v48, v17, v16, s96
  v_perm_b32 v49, v19, v18, s97
  v_or_b32 v48, v48, v49
  v_perm_b32 v50, v21, v20, s96
  v_perm_b32 v51, v23, v22, s97
  v_or_b32 v50, v50, v51
  v_perm_b32 v52, v25, v24, s96
  v_perm_b32 v53, v27, v26, s97
  v_or_b32 v52, v52, v53
  v_perm_b32 v54, v29, v28, s96
  v_perm_b32 v55, v31, v30, s97
  v_or_b32 v54, v54, v55
  v_xor_b32 v48, v48, v47
  v_xor_b32 v50, v50, v47
  v_xor_b32 v52, v52, v47
  v_xor_b32 v54, v54, v47
  v_or3_b32 v48, v48, v50, v52
  v_or_b32 v48, v48, v54
  v_cmp_ne_u32 s[90:91], 0, v48
  s_add_u32 s65, s65, 1
  s_cmp_ge_u32 s65, 200000
  s_cbranch_scc1 L_gq_ok
s_nop 0
  s_cmp_lg_u64 s[90:91], 0
  s_cbranch_scc1 L_gq_loop
L_gq_ok:
  v_mov_b32 v12, 0x80
  v_perm_b32 v16, v16, v12, s92
  v_perm_b32 v17, v17, v12, s92
  v_perm_b32 v18, v18, v12, s92
  v_perm_b32 v19, v19, v12, s92
  v_perm_b32 v20, v20, v12, s92
  v_perm_b32 v21, v21, v12, s92
  v_perm_b32 v22, v22, v12, s92
  v_perm_b32 v23, v23, v12, s92
  v_perm_b32 v24, v24, v12, s92
  v_perm_b32 v25, v25, v12, s92
  v_perm_b32 v26, v26, v12, s92
  v_perm_b32 v27, v27, v12, s92
  v_perm_b32 v28, v28, v12, s92
  v_perm_b32 v29, v29, v12, s92
  v_perm_b32 v30, v30, v12, s92
  v_perm_b32 v31, v31, v12, s92
  v_pk_add_f32 v[16:17], v[16:17], v[20:21]
  v_pk_add_f32 v[18:19], v[18:19], v[22:23]
  v_pk_add_f32 v[24:25], v[24:25], v[28:29]
  v_pk_add_f32 v[26:27], v[26:27], v[30:31]
  v_pk_add_f32 v[16:17], v[16:17], v[24:25]
  v_pk_add_f32 v[18:19], v[18:19], v[26:27]
s_nop 1
  v_permlane32_swap_b32 v16, v18
  v_permlane32_swap_b32 v17, v19
  v_add_f32 v16, v16, v18
  v_add_f32 v17, v17, v19
  v_cvt_pk_bf16_f32 v16, v16, v17
  v_and_b32 v11, 31, v1
  v_lshlrev_b32 v11, 1, v11
  v_lshrrev_b32 v12, 5, v1
  v_add_u32 v11, v11, v12
  v_lshlrev_b32 v11, 2, v11
  ds_write_b32 v11, v16 offset:4096
  v_mov_b32 v12, 0
  v_mov_b32 v17, 1
  s_mov_b64 exec, 1
  ds_add_u32 v12, v17 offset:4496
  s_mov_b64 exec, -1
L_skip6:
  s_cmp_lg_u32 s64, 2
  s_cbranch_scc1 L_skip7
  v_mov_b32 v11, 0
  s_mov_b32 s65, 0
L_e2_loop:
  ds_read_b32 v47, v11 offset:4504
  s_waitcnt lgkmcnt(0)
  v_readfirstlane_b32 s27, v47
  s_add_u32 s65, s65, 1
  s_cmp_ge_u32 s65, 200000
  s_cbranch_scc1 L_e2_ok
s_nop 0
  s_cmp_eq_u32 s27, 0
  s_cbranch_scc1 L_e2_loop
L_e2_ok:
  s_waitcnt vmcnt(7)
  s_mov_b32 s68, 0x3f3f3f3f
  s_mov_b32 s69, 0x3f3f3f3f
  v_perm_b32 v48, v17, v16, s96
  v_perm_b32 v49, v19, v18, s97
  v_or_b32 v48, v48, v49
  v_cmp_ne_u32 s[90:91], v48, v47
s_nop 3
  s_and_b64 s[90:91], s[90:91], s[68:69]
  s_cbranch_scc0 L_gh_ok
  s_mov_b32 s65, 0
L_gh_loop:
  buffer_load_dwordx4 v[16:19], v8, s[56:59], s87 offen sc1
  s_waitcnt vmcnt(0)
  v_perm_b32 v48, v17, v16, s96
  v_perm_b32 v49, v19, v18, s97
  v_or_b32 v48, v48, v49
  v_cmp_ne_u32 s[90:91], v48, v47
s_nop 3
  s_and_b64 s[90:91], s[90:91], s[68:69]
  s_cbranch_scc0 L_gh_ok
  s_add_u32 s65, s65, 1
  s_cmp_lt_u32 s65, 200000
  s_cbranch_scc1 L_gh_loop
L_gh_ok:
  v_mov_b32 v12, 0x80
  v_perm_b32 v16, v16, v12, s92
  v_perm_b32 v17, v17, v12, s92
  v_perm_b32 v18, v18, v12, s92
  v_perm_b32 v19, v19, v12, s92
s_nop 0
  v_permlane32_swap_b32 v16, v18
  v_permlane32_swap_b32 v17, v19
  v_add_f32 v16, v16, v18
  v_add_f32 v17, v17, v19
s_nop 1
  v_permlane16_swap_b32 v16, v17
  v_add_f32 v16, v16, v17
s_nop 1
  v_add_f32_dpp v16, v16, v16 row_ror:8 row_mask:0xf bank_mask:0xf
  v_cvt_pk_bf16_f32 v16, v16, v16
  v_lshlrev_b32 v16, 16, v16
  v_mul_f32 v17, 0xbfb8aa3b, v16
  v_exp_f32 v17, v17
s_nop 0
  v_add_f32 v17, 1.0, v17
  v_rcp_f32 v17, v17
s_nop 0
  v_mul_f32 v16, v16, v17
  v_cvt_pk_bf16_f32 v16, v16, v16
  v_and_b32 v11, 7, v10
  v_lshl_add_u32 v11, v11, 2, v9
  v_lshlrev_b32 v11, 1, v11
  s_mov_b32 exec_lo, 0x003f003f
  s_mov_b32 exec_hi, 0x003f003f
  ds_write_b16 v11, v16 offset:9600
  s_mov_b64 exec, -1
  v_mov_b32 v12, 0
  v_mov_b32 v17, 1
  s_mov_b64 exec, 1
  ds_add_u32 v12, v17 offset:4488
  s_mov_b64 exec, -1
L_skip7:
  s_waitcnt vmcnt(5)
  buffer_load_dwordx4 v[188:191], v2, s[28:31], s84 offen nt
  s_add_u32 s84, s84, 8192
  s_waitcnt vmcnt(5)
  ds_write_b128 v4, v[64:67] offset:0
  ds_write_b128 v4, v[68:71] offset:1152
  ds_write_b128 v4, v[72:75] offset:2304
  v_mov_b32 v76, 0
  v_mov_b32 v77, 0
  v_mov_b32 v78, 0
  v_mov_b32 v79, 0
  ds_write_b128 v4, v[76:79] offset:3456
  ds_read_b64_tr_b16 v[64:65], v5 offset:0
  ds_read_b64_tr_b16 v[66:67], v5 offset:576
  ds_read_b64_tr_b16 v[68:69], v5 offset:32
  ds_read_b64_tr_b16 v[70:71], v5 offset:608
  ds_read_b64_tr_b16 v[72:73], v5 offset:64
  ds_read_b64_tr_b16 v[74:75], v5 offset:640
  ds_read_b64_tr_b16 v[76:77], v5 offset:96
  ds_read_b64_tr_b16 v[78:79], v5 offset:672
  buffer_load_dwordx4 v[192:195], v2, s[28:31], s84 offen nt
  s_add_u32 s84, s84, 8192
  s_waitcnt vmcnt(5)
  buffer_load_dwordx4 v[196:199], v2, s[28:31], s84 offen nt
  s_add_u32 s84, s84, 8192
  s_waitcnt vmcnt(5)
  buffer_load_dwordx4 v[212:215], v6, s[48:51], s83 offen nt
  s_add_u32 s83, s83, 8192
  s_waitcnt vmcnt(5)
  buffer_load_dwordx4 v[200:203], v2, s[28:31], s84 offen nt
  s_add_u32 s84, s84, 8192
  s_waitcnt vmcnt(5)
  buffer_load_dwordx4 v[204:207], v2, s[28:31], s84 offen nt
  v_mov_b32 v11, 0
  s_mov_b32 s65, 0
L_q_loop:
  ds_read_b32 v12, v11 offset:4496
  s_waitcnt lgkmcnt(0)
  v_readfirstlane_b32 s66, v12
  s_add_u32 s65, s65, 1
  s_cmp_ge_u32 s65, 200000
  s_cbranch_scc1 L_q_ok
s_nop 0
  s_cmp_lg_u32 s66, 1
  s_cbranch_scc1 L_q_loop
L_q_ok:
  v_lshlrev_b32 v11, 4, v10
  ds_read_b128 v[32:35], v11 offset:4096
  v_mov_b32 v12, 0
  ds_read_b32 v47, v12 offset:4504
  s_waitcnt lgkmcnt(0)
  v_readfirstlane_b32 s27, v47
  v_dot2_f32_bf16 v48, v80, v32, 0
  v_dot2_f32_bf16 v48, v81, v33, v48
  v_dot2_f32_bf16 v48, v82, v34, v48
  v_dot2_f32_bf16 v48, v83, v35, v48
  v_dot2_f32_bf16 v49, v84, v32, 0
  v_dot2_f32_bf16 v49, v85, v33, v49
  v_dot2_f32_bf16 v49, v86, v34, v49
  v_dot2_f32_bf16 v49, v87, v35, v49
  v_dot2_f32_bf16 v50, v88, v32, 0
  v_dot2_f32_bf16 v50, v89, v33, v50
  v_dot2_f32_bf16 v50, v90, v34, v50
  v_dot2_f32_bf16 v50, v91, v35, v50
  v_dot2_f32_bf16 v51, v92, v32, 0
  v_dot2_f32_bf16 v51, v93, v33, v51
  v_dot2_f32_bf16 v51, v94, v34, v51
  v_dot2_f32_bf16 v51, v95, v35, v51
  v_dot2_f32_bf16 v52, v96, v32, 0
  v_dot2_f32_bf16 v52, v97, v33, v52
  v_dot2_f32_bf16 v52, v98, v34, v52
  v_dot2_f32_bf16 v52, v99, v35, v52
  v_dot2_f32_bf16 v53, v100, v32, 0
  v_dot2_f32_bf16 v53, v101, v33, v53
  v_dot2_f32_bf16 v53, v102, v34, v53
  v_dot2_f32_bf16 v53, v103, v35, v53
  v_dot2_f32_bf16 v54, v104, v32, 0
  v_dot2_f32_bf16 v54, v105, v33, v54
  v_dot2_f32_bf16 v54, v106, v34, v54
  v_dot2_f32_bf16 v54, v107, v35, v54
  v_dot2_f32_bf16 v55, v108, v32, 0
  v_dot2_f32_bf16 v55, v109, v33, v55
  v_dot2_f32_bf16 v55, v110, v34, v55
  v_dot2_f32_bf16 v55, v111, v35, v55
  v_dot2_f32_bf16 v56, v112, v32, 0
  v_dot2_f32_bf16 v56, v113, v33, v56
  v_dot2_f32_bf16 v56, v114, v34, v56
  v_dot2_f32_bf16 v56, v115, v35, v56
  v_dot2_f32_bf16 v57, v116, v32, 0
  v_dot2_f32_bf16 v57, v117, v33, v57
  v_dot2_f32_bf16 v57, v118, v34, v57
  v_dot2_f32_bf16 v57, v119, v35, v57
  v_dot2_f32_bf16 v58, v120, v32, 0
  v_dot2_f32_bf16 v58, v121, v33, v58
  v_dot2_f32_bf16 v58, v122, v34, v58
  v_dot2_f32_bf16 v58, v123, v35, v58
  v_dot2_f32_bf16 v59, v124, v32, 0
  v_dot2_f32_bf16 v59, v125, v33, v59
  v_dot2_f32_bf16 v59, v126, v34, v59
  v_dot2_f32_bf16 v59, v127, v35, v59
  v_dot2_f32_bf16 v60, v128, v32, 0
  v_dot2_f32_bf16 v60, v129, v33, v60
  v_dot2_f32_bf16 v60, v130, v34, v60
  v_dot2_f32_bf16 v60, v131, v35, v60
  v_dot2_f32_bf16 v61, v132, v32, 0
  v_dot2_f32_bf16 v61, v133, v33, v61
  v_dot2_f32_bf16 v61, v134, v34, v61
  v_dot2_f32_bf16 v61, v135, v35, v61
  v_dot2_f32_bf16 v62, v136, v32, 0
  v_dot2_f32_bf16 v62, v137, v33, v62
  v_dot2_f32_bf16 v62, v138, v34, v62
  v_dot2_f32_bf16 v62, v139, v35, v62
  v_dot2_f32_bf16 v63, v140, v32, 0
  v_dot2_f32_bf16 v63, v141, v33, v63
  v_dot2_f32_bf16 v63, v142, v34, v63
  v_dot2_f32_bf16 v63, v143, v35, v63
  v_add_f32_dpp v48, v48, v48 row_ror:8 row_mask:0xf bank_mask:0x3
  v_add_f32_dpp v49, v49, v49 row_ror:8 row_mask:0xf bank_mask:0x3
  v_add_f32_dpp v50, v50, v50 row_ror:8 row_mask:0xf bank_mask:0x3
  v_add_f32_dpp v51, v51, v51 row_ror:8 row_mask:0xf bank_mask:0x3
  v_add_f32_dpp v52, v52, v52 row_ror:8 row_mask:0xf bank_mask:0x3
  v_add_f32_dpp v53, v53, v53 row_ror:8 row_mask:0xf bank_mask:0x3
  v_add_f32_dpp v54, v54, v54 row_ror:8 row_mask:0xf bank_mask:0x3
  v_add_f32_dpp v55, v55, v55 row_ror:8 row_mask:0xf bank_mask:0x3
  v_add_f32_dpp v48, v56, v56 row_ror:8 row_mask:0xf bank_mask:0xc
  v_add_f32_dpp v49, v57, v57 row_ror:8 row_mask:0xf bank_mask:0xc
  v_add_f32_dpp v50, v58, v58 row_ror:8 row_mask:0xf bank_mask:0xc
  v_add_f32_dpp v51, v59, v59 row_ror:8 row_mask:0xf bank_mask:0xc
  v_add_f32_dpp v52, v60, v60 row_ror:8 row_mask:0xf bank_mask:0xc
  v_add_f32_dpp v53, v61, v61 row_ror:8 row_mask:0xf bank_mask:0xc
  v_add_f32_dpp v54, v62, v62 row_ror:8 row_mask:0xf bank_mask:0xc
  v_add_f32_dpp v55, v63, v63 row_ror:8 row_mask:0xf bank_mask:0xc
  v_add_f32_dpp v48, v48, v48 row_shl:4 row_mask:0xf bank_mask:0x5
  v_add_f32_dpp v49, v49, v49 row_shl:4 row_mask:0xf bank_mask:0x5
  v_add_f32_dpp v50, v50, v50 row_shl:4 row_mask:0xf bank_mask:0x5
  v_add_f32_dpp v51, v51, v51 row_shl:4 row_mask:0xf bank_mask:0x5
  v_add_f32_dpp v48, v52, v52 row_shr:4 row_mask:0xf bank_mask:0xa
  v_add_f32_dpp v49, v53, v53 row_shr:4 row_mask:0xf bank_mask:0xa
  v_add_f32_dpp v50, v54, v54 row_shr:4 row_mask:0xf bank_mask:0xa
  v_add_f32_dpp v51, v55, v55 row_shr:4 row_mask:0xf bank_mask:0xa
  v_add_f32_dpp v48, v48, v48 quad_perm:[2,3,0,1] row_mask:0xf bank_mask:0xf
  v_add_f32_dpp v49, v49, v49 quad_perm:[2,3,0,1] row_mask:0xf bank_mask:0xf
  v_add_f32_dpp v50, v50, v50 quad_perm:[2,3,0,1] row_mask:0xf bank_mask:0xf
  v_add_f32_dpp v51, v51, v51 quad_perm:[2,3,0,1] row_mask:0xf bank_mask:0xf
  v_cndmask_b32 v48, v48, v50, s[72:73]
  v_cndmask_b32 v49, v49, v51, s[72:73]
s_nop 0
  v_add_f32_dpp v48, v48, v48 quad_perm:[1,0,3,2] row_mask:0xf bank_mask:0xf
  v_add_f32_dpp v49, v49, v49 quad_perm:[1,0,3,2] row_mask:0xf bank_mask:0xf
  v_cndmask_b32 v40, v48, v49, s[70:71]
  v_dot2_f32_bf16 v48, v144, v32, 0
  v_dot2_f32_bf16 v48, v145, v33, v48
  v_dot2_f32_bf16 v48, v146, v34, v48
  v_dot2_f32_bf16 v48, v147, v35, v48
  v_dot2_f32_bf16 v49, v148, v32, 0
  v_dot2_f32_bf16 v49, v149, v33, v49
  v_dot2_f32_bf16 v49, v150, v34, v49
  v_dot2_f32_bf16 v49, v151, v35, v49
  v_dot2_f32_bf16 v50, v152, v32, 0
  v_dot2_f32_bf16 v50, v153, v33, v50
  v_dot2_f32_bf16 v50, v154, v34, v50
  v_dot2_f32_bf16 v50, v155, v35, v50
  v_dot2_f32_bf16 v51, v156, v32, 0
  v_dot2_f32_bf16 v51, v157, v33, v51
  v_dot2_f32_bf16 v51, v158, v34, v51
  v_dot2_f32_bf16 v51, v159, v35, v51
  v_dot2_f32_bf16 v52, v160, v32, 0
  v_dot2_f32_bf16 v52, v161, v33, v52
  v_dot2_f32_bf16 v52, v162, v34, v52
  v_dot2_f32_bf16 v52, v163, v35, v52
  v_dot2_f32_bf16 v53, v164, v32, 0
  v_dot2_f32_bf16 v53, v165, v33, v53
  v_dot2_f32_bf16 v53, v166, v34, v53
  v_dot2_f32_bf16 v53, v167, v35, v53
  v_dot2_f32_bf16 v54, v168, v32, 0
  v_dot2_f32_bf16 v54, v169, v33, v54
  v_dot2_f32_bf16 v54, v170, v34, v54
  v_dot2_f32_bf16 v54, v171, v35, v54
  v_dot2_f32_bf16 v55, v172, v32, 0
  v_dot2_f32_bf16 v55, v173, v33, v55
  v_dot2_f32_bf16 v55, v174, v34, v55
  v_dot2_f32_bf16 v55, v175, v35, v55
  v_dot2_f32_bf16 v56, v176, v32, 0
  v_dot2_f32_bf16 v56, v177, v33, v56
  v_dot2_f32_bf16 v56, v178, v34, v56
  v_dot2_f32_bf16 v56, v179, v35, v56
  v_dot2_f32_bf16 v57, v180, v32, 0
  v_dot2_f32_bf16 v57, v181, v33, v57
  v_dot2_f32_bf16 v57, v182, v34, v57
  v_dot2_f32_bf16 v57, v183, v35, v57
  v_dot2_f32_bf16 v58, v184, v32, 0
  v_dot2_f32_bf16 v58, v185, v33, v58
  v_dot2_f32_bf16 v58, v186, v34, v58
  v_dot2_f32_bf16 v58, v187, v35, v58
  s_waitcnt vmcnt(5)
  v_dot2_f32_bf16 v59, v188, v32, 0
  v_dot2_f32_bf16 v59, v189, v33, v59
  v_dot2_f32_bf16 v59, v190, v34, v59
  v_dot2_f32_bf16 v59, v191, v35, v59
  buffer_load_dwordx4 v[80:83], v2, s[32:35], s85 offen nt
  s_add_u32 s85, s85, 8192
  s_waitcnt vmcnt(5)
  v_dot2_f32_bf16 v60, v192, v32, 0
  v_dot2_f32_bf16 v60, v193, v33, v60
  v_dot2_f32_bf16 v60, v194, v34, v60
  v_dot2_f32_bf16 v60, v195, v35, v60
  buffer_load_dwordx4 v[84:87], v2, s[32:35], s85 offen nt
  s_add_u32 s85, s85, 8192
  s_waitcnt vmcnt(5)
  v_dot2_f32_bf16 v61, v196, v32, 0
  v_dot2_f32_bf16 v61, v197, v33, v61
  v_dot2_f32_bf16 v61, v198, v34, v61
  v_dot2_f32_bf16 v61, v199, v35, v61
  buffer_load_dwordx4 v[216:219], v6, s[48:51], s83 offen nt
  s_add_u32 s83, s83, 8192
  s_waitcnt vmcnt(5)
  buffer_load_dwordx4 v[88:91], v2, s[32:35], s85 offen nt
  s_add_u32 s85, s85, 8192
  s_waitcnt vmcnt(5)
  v_dot2_f32_bf16 v62, v200, v32, 0
  v_dot2_f32_bf16 v62, v201, v33, v62
  v_dot2_f32_bf16 v62, v202, v34, v62
  v_dot2_f32_bf16 v62, v203, v35, v62
  buffer_load_dwordx4 v[92:95], v2, s[32:35], s85 offen nt
  s_add_u32 s85, s85, 8192
  s_waitcnt vmcnt(5)
  v_dot2_f32_bf16 v63, v204, v32, 0
  v_dot2_f32_bf16 v63, v205, v33, v63
  v_dot2_f32_bf16 v63, v206, v34, v63
  v_dot2_f32_bf16 v63, v207, v35, v63
  buffer_load_dwordx4 v[220:223], v6, s[48:51], s83 offen nt
  s_add_u32 s83, s83, 8192
  v_add_f32_dpp v48, v48, v48 row_ror:8 row_mask:0xf bank_mask:0x3
  v_add_f32_dpp v49, v49, v49 row_ror:8 row_mask:0xf bank_mask:0x3
  v_add_f32_dpp v50, v50, v50 row_ror:8 row_mask:0xf bank_mask:0x3
  v_add_f32_dpp v51, v51, v51 row_ror:8 row_mask:0xf bank_mask:0x3
  v_add_f32_dpp v52, v52, v52 row_ror:8 row_mask:0xf bank_mask:0x3
  v_add_f32_dpp v53, v53, v53 row_ror:8 row_mask:0xf bank_mask:0x3
  v_add_f32_dpp v54, v54, v54 row_ror:8 row_mask:0xf bank_mask:0x3
  v_add_f32_dpp v55, v55, v55 row_ror:8 row_mask:0xf bank_mask:0x3
  v_add_f32_dpp v48, v56, v56 row_ror:8 row_mask:0xf bank_mask:0xc
  v_add_f32_dpp v49, v57, v57 row_ror:8 row_mask:0xf bank_mask:0xc
  v_add_f32_dpp v50, v58, v58 row_ror:8 row_mask:0xf bank_mask:0xc
  v_add_f32_dpp v51, v59, v59 row_ror:8 row_mask:0xf bank_mask:0xc
  v_add_f32_dpp v52, v60, v60 row_ror:8 row_mask:0xf bank_mask:0xc
  v_add_f32_dpp v53, v61, v61 row_ror:8 row_mask:0xf bank_mask:0xc
  v_add_f32_dpp v54, v62, v62 row_ror:8 row_mask:0xf bank_mask:0xc
  v_add_f32_dpp v55, v63, v63 row_ror:8 row_mask:0xf bank_mask:0xc
  v_add_f32_dpp v48, v48, v48 row_shl:4 row_mask:0xf bank_mask:0x5
  v_add_f32_dpp v49, v49, v49 row_shl:4 row_mask:0xf bank_mask:0x5
  v_add_f32_dpp v50, v50, v50 row_shl:4 row_mask:0xf bank_mask:0x5
  v_add_f32_dpp v51, v51, v51 row_shl:4 row_mask:0xf bank_mask:0x5
  v_add_f32_dpp v48, v52, v52 row_shr:4 row_mask:0xf bank_mask:0xa
  v_add_f32_dpp v49, v53, v53 row_shr:4 row_mask:0xf bank_mask:0xa
  v_add_f32_dpp v50, v54, v54 row_shr:4 row_mask:0xf bank_mask:0xa
  v_add_f32_dpp v51, v55, v55 row_shr:4 row_mask:0xf bank_mask:0xa
  v_add_f32_dpp v48, v48, v48 quad_perm:[2,3,0,1] row_mask:0xf bank_mask:0xf
  v_add_f32_dpp v49, v49, v49 quad_perm:[2,3,0,1] row_mask:0xf bank_mask:0xf
  v_add_f32_dpp v50, v50, v50 quad_perm:[2,3,0,1] row_mask:0xf bank_mask:0xf
  v_add_f32_dpp v51, v51, v51 quad_perm:[2,3,0,1] row_mask:0xf bank_mask:0xf
  v_cndmask_b32 v48, v48, v50, s[72:73]
  v_cndmask_b32 v49, v49, v51, s[72:73]
s_nop 0
  v_add_f32_dpp v48, v48, v48 quad_perm:[1,0,3,2] row_mask:0xf bank_mask:0xf
  v_add_f32_dpp v49, v49, v49 quad_perm:[1,0,3,2] row_mask:0xf bank_mask:0xf
  v_cndmask_b32 v41, v48, v49, s[70:71]
  v_cvt_pk_bf16_f32 v48, v40, v41
  v_lshlrev_b32 v40, 16, v48
  v_and_b32 v41, 0xffff0000, v48
  v_mul_f32 v40, 0x3db504f3, v40
  v_mul_f32 v41, 0x3db504f3, v41
  v_cvt_pk_bf16_f32 v48, v40, v41
  v_lshlrev_b32 v40, 16, v48
  v_and_b32 v41, 0xffff0000, v48
  v_max_f32 v48, v40, v41
s_nop 1
  v_max_f32_dpp v48, v48, v48 quad_perm:[1,0,3,2] row_mask:0xf bank_mask:0xf
s_nop 1
  v_max_f32_dpp v48, v48, v48 quad_perm:[2,3,0,1] row_mask:0xf bank_mask:0xf
s_nop 1
  v_max_f32_dpp v48, v48, v48 row_half_mirror row_mask:0xf bank_mask:0xf
s_nop 1
  v_max_f32_dpp v48, v48, v48 row_mirror row_mask:0xf bank_mask:0xf
s_nop 1
  v_max_f32_dpp v48, v48, v48 row_bcast:15 row_mask:0xa bank_mask:0xf
s_nop 1
  v_max_f32_dpp v48, v48, v48 row_bcast:31 row_mask:0xc bank_mask:0xf
s_nop 0
  v_readlane_b32 s65, v48, 63
s_nop 1
  v_subrev_f32 v40, s65, v40
  v_subrev_f32 v41, s65, v41
  v_mul_f32 v40, 0x3fb8aa3b, v40
  v_mul_f32 v41, 0x3fb8aa3b, v41
  v_exp_f32 v40, v40
  v_exp_f32 v41, v41
s_nop 0
  v_cvt_pk_bf16_f32 v48, v40, v41
  v_and_b32 v42, 0xffff, v48
  v_lshlrev_b32 v43, 16, v48
  v_lshrrev_b32 v44, 16, v48
  v_and_b32 v45, 0xffff0000, v48
  v_add_f32 v49, v40, v41
s_nop 1
  v_add_f32_dpp v49, v49, v49 quad_perm:[1,0,3,2] row_mask:0xf bank_mask:0xf
s_nop 1
  v_add_f32_dpp v49, v49, v49 quad_perm:[2,3,0,1] row_mask:0xf bank_mask:0xf
s_nop 1
  v_add_f32_dpp v49, v49, v49 row_half_mirror row_mask:0xf bank_mask:0xf
s_nop 1
  v_add_f32_dpp v49, v49, v49 row_mirror row_mask:0xf bank_mask:0xf
s_nop 1
  v_add_f32_dpp v49, v49, v49 row_bcast:15 row_mask:0xa bank_mask:0xf
s_nop 1
  v_add_f32_dpp v49, v49, v49 row_bcast:31 row_mask:0xc bank_mask:0xf
s_nop 0
  v_readlane_b32 s66, v49, 63
  v_mov_b32 v50, s65
s_nop 0
  v_mov_b32 v51, s66
  v_lshlrev_b32 v11, 3, v7
  ds_write_b64 v11, v[50:51] offset:4352
  v_mov_b32 v12, 0
  v_mov_b32 v52, 1
  s_mov_b64 exec, 1
  ds_add_u32 v12, v52 offset:4480
  s_mov_b64 exec, -1
  v_mov_b32 v16, 0
  v_mov_b32 v17, 0
  v_mov_b32 v18, 0
  v_mov_b32 v19, 0
  v_mov_b32 v20, 0
  v_mov_b32 v21, 0
  v_mov_b32 v22, 0
  v_mov_b32 v23, 0
  v_mov_b32 v11, 0
  s_mov_b32 s65, 0
L_h_loop:
  ds_read_b32 v12, v11 offset:4488
  s_waitcnt lgkmcnt(0)
  v_readfirstlane_b32 s66, v12
  s_add_u32 s65, s65, 1
  s_cmp_ge_u32 s65, 200000
  s_cbranch_scc1 L_h_ok
s_nop 0
  s_cmp_lg_u32 s66, 1
  s_cbranch_scc1 L_h_loop
L_h_ok:
  v_mul_u32_u24 v12, 80, v10
  v_lshl_add_u32 v12, v9, 4, v12
  ds_read_b128 v[48:51], v12 offset:8960
  s_waitcnt lgkmcnt(0)
  v_mfma_f32_16x16x32_bf16 v[24:27], v[48:51], v[64:67], 0
  v_mfma_f32_16x16x32_bf16 v[28:31], v[48:51], v[68:71], 0
  v_mfma_f32_16x16x32_bf16 v[32:35], v[48:51], v[72:75], 0
  v_mfma_f32_16x16x32_bf16 v[36:39], v[48:51], v[76:79], 0
  s_lshl_b32 s67, s60, 6
  s_add_u32 s67, s67, s63
  s_waitcnt vmcnt(5)
  v_dot2c_f32_bf16_dpp v16, v42, v80 row_newbcast:0 row_mask:0xf bank_mask:0xf
  v_dot2c_f32_bf16_dpp v17, v43, v80 row_newbcast:0 row_mask:0xf bank_mask:0xf
  v_dot2c_f32_bf16_dpp v18, v42, v81 row_newbcast:0 row_mask:0xf bank_mask:0xf
  v_dot2c_f32_bf16_dpp v19, v43, v81 row_newbcast:0 row_mask:0xf bank_mask:0xf
  v_dot2c_f32_bf16_dpp v20, v42, v82 row_newbcast:0 row_mask:0xf bank_mask:0xf
  v_dot2c_f32_bf16_dpp v21, v43, v82 row_newbcast:0 row_mask:0xf bank_mask:0xf
  v_dot2c_f32_bf16_dpp v22, v42, v83 row_newbcast:0 row_mask:0xf bank_mask:0xf
  v_dot2c_f32_bf16_dpp v23, v43, v83 row_newbcast:0 row_mask:0xf bank_mask:0xf
  buffer_load_dwordx4 v[96:99], v2, s[32:35], s85 offen nt
  s_add_u32 s85, s85, 8192
  s_waitcnt vmcnt(5)
  v_dot2c_f32_bf16_dpp v16, v42, v84 row_newbcast:1 row_mask:0xf bank_mask:0xf
  v_dot2c_f32_bf16_dpp v17, v43, v84 row_newbcast:1 row_mask:0xf bank_mask:0xf
  v_dot2c_f32_bf16_dpp v18, v42, v85 row_newbcast:1 row_mask:0xf bank_mask:0xf
  v_dot2c_f32_bf16_dpp v19, v43, v85 row_newbcast:1 row_mask:0xf bank_mask:0xf
  v_dot2c_f32_bf16_dpp v20, v42, v86 row_newbcast:1 row_mask:0xf bank_mask:0xf
  v_dot2c_f32_bf16_dpp v21, v43, v86 row_newbcast:1 row_mask:0xf bank_mask:0xf
  v_dot2c_f32_bf16_dpp v22, v42, v87 row_newbcast:1 row_mask:0xf bank_mask:0xf
  v_dot2c_f32_bf16_dpp v23, v43, v87 row_newbcast:1 row_mask:0xf bank_mask:0xf
  buffer_load_dwordx4 v[100:103], v2, s[32:35], s85 offen nt
  s_add_u32 s85, s85, 8192
  s_waitcnt vmcnt(5)
  buffer_load_dwordx4 v[224:227], v6, s[48:51], s83 offen nt
  s_add_u32 s83, s83, 8192
  s_waitcnt vmcnt(5)
  v_dot2c_f32_bf16_dpp v16, v42, v88 row_newbcast:2 row_mask:0xf bank_mask:0xf
  v_dot2c_f32_bf16_dpp v17, v43, v88 row_newbcast:2 row_mask:0xf bank_mask:0xf
  v_dot2c_f32_bf16_dpp v18, v42, v89 row_newbcast:2 row_mask:0xf bank_mask:0xf
  v_dot2c_f32_bf16_dpp v19, v43, v89 row_newbcast:2 row_mask:0xf bank_mask:0xf
  v_dot2c_f32_bf16_dpp v20, v42, v90 row_newbcast:2 row_mask:0xf bank_mask:0xf
  v_dot2c_f32_bf16_dpp v21, v43, v90 row_newbcast:2 row_mask:0xf bank_mask:0xf
  v_dot2c_f32_bf16_dpp v22, v42, v91 row_newbcast:2 row_mask:0xf bank_mask:0xf
  v_dot2c_f32_bf16_dpp v23, v43, v91 row_newbcast:2 row_mask:0xf bank_mask:0xf
  buffer_load_dwordx4 v[104:107], v2, s[32:35], s85 offen nt
  s_add_u32 s85, s85, 8192
  s_waitcnt vmcnt(5)
  v_dot2c_f32_bf16_dpp v16, v42, v92 row_newbcast:3 row_mask:0xf bank_mask:0xf
  v_dot2c_f32_bf16_dpp v17, v43, v92 row_newbcast:3 row_mask:0xf bank_mask:0xf
  v_dot2c_f32_bf16_dpp v18, v42, v93 row_newbcast:3 row_mask:0xf bank_mask:0xf
  v_dot2c_f32_bf16_dpp v19, v43, v93 row_newbcast:3 row_mask:0xf bank_mask:0xf
  v_dot2c_f32_bf16_dpp v20, v42, v94 row_newbcast:3 row_mask:0xf bank_mask:0xf
  v_dot2c_f32_bf16_dpp v21, v43, v94 row_newbcast:3 row_mask:0xf bank_mask:0xf
  v_dot2c_f32_bf16_dpp v22, v42, v95 row_newbcast:3 row_mask:0xf bank_mask:0xf
  v_dot2c_f32_bf16_dpp v23, v43, v95 row_newbcast:3 row_mask:0xf bank_mask:0xf
  buffer_load_dwordx4 v[108:111], v2, s[32:35], s85 offen nt
  s_add_u32 s85, s85, 8192
  s_waitcnt vmcnt(5)
  ds_write_b128 v4, v[208:211] offset:0
  ds_write_b128 v4, v[212:215] offset:1152
  ds_write_b128 v4, v[216:219] offset:2304
  ds_write_b128 v4, v[220:223] offset:3456
  ds_read_b64_tr_b16 v[208:209], v5 offset:0
  ds_read_b64_tr_b16 v[210:211], v5 offset:576
  ds_read_b64_tr_b16 v[212:213], v5 offset:32
  ds_read_b64_tr_b16 v[214:215], v5 offset:608
  ds_read_b64_tr_b16 v[216:217], v5 offset:64
  ds_read_b64_tr_b16 v[218:219], v5 offset:640
  ds_read_b64_tr_b16 v[220:221], v5 offset:96
  ds_read_b64_tr_b16 v[222:223], v5 offset:672
  buffer_load_dwordx4 v[228:231], v6, s[48:51], s83 offen nt
  s_add_u32 s83, s83, 8192
  s_waitcnt vmcnt(5)
  v_dot2c_f32_bf16_dpp v16, v42, v96 row_newbcast:4 row_mask:0xf bank_mask:0xf
  v_dot2c_f32_bf16_dpp v17, v43, v96 row_newbcast:4 row_mask:0xf bank_mask:0xf
  v_dot2c_f32_bf16_dpp v18, v42, v97 row_newbcast:4 row_mask:0xf bank_mask:0xf
  v_dot2c_f32_bf16_dpp v19, v43, v97 row_newbcast:4 row_mask:0xf bank_mask:0xf
  v_dot2c_f32_bf16_dpp v20, v42, v98 row_newbcast:4 row_mask:0xf bank_mask:0xf
  v_dot2c_f32_bf16_dpp v21, v43, v98 row_newbcast:4 row_mask:0xf bank_mask:0xf
  v_dot2c_f32_bf16_dpp v22, v42, v99 row_newbcast:4 row_mask:0xf bank_mask:0xf
  v_dot2c_f32_bf16_dpp v23, v43, v99 row_newbcast:4 row_mask:0xf bank_mask:0xf
  buffer_load_dwordx4 v[112:115], v2, s[32:35], s85 offen nt
  s_add_u32 s85, s85, 8192
  s_waitcnt vmcnt(5)
  v_dot2c_f32_bf16_dpp v16, v42, v100 row_newbcast:5 row_mask:0xf bank_mask:0xf
  v_dot2c_f32_bf16_dpp v17, v43, v100 row_newbcast:5 row_mask:0xf bank_mask:0xf
  v_dot2c_f32_bf16_dpp v18, v42, v101 row_newbcast:5 row_mask:0xf bank_mask:0xf
  v_dot2c_f32_bf16_dpp v19, v43, v101 row_newbcast:5 row_mask:0xf bank_mask:0xf
  v_dot2c_f32_bf16_dpp v20, v42, v102 row_newbcast:5 row_mask:0xf bank_mask:0xf
  v_dot2c_f32_bf16_dpp v21, v43, v102 row_newbcast:5 row_mask:0xf bank_mask:0xf
  v_dot2c_f32_bf16_dpp v22, v42, v103 row_newbcast:5 row_mask:0xf bank_mask:0xf
  v_dot2c_f32_bf16_dpp v23, v43, v103 row_newbcast:5 row_mask:0xf bank_mask:0xf
  buffer_load_dwordx4 v[116:119], v2, s[32:35], s85 offen nt
  s_add_u32 s85, s85, 8192
  s_waitcnt vmcnt(5)
  buffer_load_dwordx4 v[232:235], v6, s[48:51], s83 offen nt
  s_add_u32 s83, s83, 8192
  s_waitcnt vmcnt(5)
  v_dot2c_f32_bf16_dpp v16, v42, v104 row_newbcast:6 row_mask:0xf bank_mask:0xf
  v_dot2c_f32_bf16_dpp v17, v43, v104 row_newbcast:6 row_mask:0xf bank_mask:0xf
  v_dot2c_f32_bf16_dpp v18, v42, v105 row_newbcast:6 row_mask:0xf bank_mask:0xf
  v_dot2c_f32_bf16_dpp v19, v43, v105 row_newbcast:6 row_mask:0xf bank_mask:0xf
  v_dot2c_f32_bf16_dpp v20, v42, v106 row_newbcast:6 row_mask:0xf bank_mask:0xf
  v_dot2c_f32_bf16_dpp v21, v43, v106 row_newbcast:6 row_mask:0xf bank_mask:0xf
  v_dot2c_f32_bf16_dpp v22, v42, v107 row_newbcast:6 row_mask:0xf bank_mask:0xf
  v_dot2c_f32_bf16_dpp v23, v43, v107 row_newbcast:6 row_mask:0xf bank_mask:0xf
  buffer_load_dwordx4 v[120:123], v2, s[32:35], s85 offen nt
  s_add_u32 s85, s85, 8192
  s_waitcnt vmcnt(5)
  v_dot2c_f32_bf16_dpp v16, v42, v108 row_newbcast:7 row_mask:0xf bank_mask:0xf
  v_dot2c_f32_bf16_dpp v17, v43, v108 row_newbcast:7 row_mask:0xf bank_mask:0xf
  v_dot2c_f32_bf16_dpp v18, v42, v109 row_newbcast:7 row_mask:0xf bank_mask:0xf
  v_dot2c_f32_bf16_dpp v19, v43, v109 row_newbcast:7 row_mask:0xf bank_mask:0xf
  v_dot2c_f32_bf16_dpp v20, v42, v110 row_newbcast:7 row_mask:0xf bank_mask:0xf
  v_dot2c_f32_bf16_dpp v21, v43, v110 row_newbcast:7 row_mask:0xf bank_mask:0xf
  v_dot2c_f32_bf16_dpp v22, v42, v111 row_newbcast:7 row_mask:0xf bank_mask:0xf
  v_dot2c_f32_bf16_dpp v23, v43, v111 row_newbcast:7 row_mask:0xf bank_mask:0xf
  buffer_load_dwordx4 v[124:127], v2, s[32:35], s85 offen nt
  s_add_u32 s85, s85, 8192
  s_waitcnt vmcnt(5)
  buffer_load_dwordx4 v[236:239], v6, s[48:51], s83 offen nt
  s_add_u32 s83, s83, 8192
  s_waitcnt vmcnt(5)
  v_dot2c_f32_bf16_dpp v16, v42, v112 row_newbcast:8 row_mask:0xf bank_mask:0xf
  v_dot2c_f32_bf16_dpp v17, v43, v112 row_newbcast:8 row_mask:0xf bank_mask:0xf
  v_dot2c_f32_bf16_dpp v18, v42, v113 row_newbcast:8 row_mask:0xf bank_mask:0xf
  v_dot2c_f32_bf16_dpp v19, v43, v113 row_newbcast:8 row_mask:0xf bank_mask:0xf
  v_dot2c_f32_bf16_dpp v20, v42, v114 row_newbcast:8 row_mask:0xf bank_mask:0xf
  v_dot2c_f32_bf16_dpp v21, v43, v114 row_newbcast:8 row_mask:0xf bank_mask:0xf
  v_dot2c_f32_bf16_dpp v22, v42, v115 row_newbcast:8 row_mask:0xf bank_mask:0xf
  v_dot2c_f32_bf16_dpp v23, v43, v115 row_newbcast:8 row_mask:0xf bank_mask:0xf
  buffer_load_dwordx4 v[128:131], v2, s[32:35], s85 offen nt
  s_add_u32 s85, s85, 8192
  s_waitcnt vmcnt(5)
  v_dot2c_f32_bf16_dpp v16, v42, v116 row_newbcast:9 row_mask:0xf bank_mask:0xf
  v_dot2c_f32_bf16_dpp v17, v43, v116 row_newbcast:9 row_mask:0xf bank_mask:0xf
  v_dot2c_f32_bf16_dpp v18, v42, v117 row_newbcast:9 row_mask:0xf bank_mask:0xf
  v_dot2c_f32_bf16_dpp v19, v43, v117 row_newbcast:9 row_mask:0xf bank_mask:0xf
  v_dot2c_f32_bf16_dpp v20, v42, v118 row_newbcast:9 row_mask:0xf bank_mask:0xf
  v_dot2c_f32_bf16_dpp v21, v43, v118 row_newbcast:9 row_mask:0xf bank_mask:0xf
  v_dot2c_f32_bf16_dpp v22, v42, v119 row_newbcast:9 row_mask:0xf bank_mask:0xf
  v_dot2c_f32_bf16_dpp v23, v43, v119 row_newbcast:9 row_mask:0xf bank_mask:0xf
  buffer_load_dwordx4 v[132:135], v2, s[32:35], s85 offen nt
  s_add_u32 s85, s85, 8192
  s_waitcnt vmcnt(5)
  buffer_load_dwordx4 v[240:243], v6, s[48:51], s83 offen nt
  s_add_u32 s83, s83, 8192
  s_waitcnt vmcnt(5)
  v_dot2c_f32_bf16_dpp v16, v42, v120 row_newbcast:10 row_mask:0xf bank_mask:0xf
  v_dot2c_f32_bf16_dpp v17, v43, v120 row_newbcast:10 row_mask:0xf bank_mask:0xf
  v_dot2c_f32_bf16_dpp v18, v42, v121 row_newbcast:10 row_mask:0xf bank_mask:0xf
  v_dot2c_f32_bf16_dpp v19, v43, v121 row_newbcast:10 row_mask:0xf bank_mask:0xf
  v_dot2c_f32_bf16_dpp v20, v42, v122 row_newbcast:10 row_mask:0xf bank_mask:0xf
  v_dot2c_f32_bf16_dpp v21, v43, v122 row_newbcast:10 row_mask:0xf bank_mask:0xf
  v_dot2c_f32_bf16_dpp v22, v42, v123 row_newbcast:10 row_mask:0xf bank_mask:0xf
  v_dot2c_f32_bf16_dpp v23, v43, v123 row_newbcast:10 row_mask:0xf bank_mask:0xf
  buffer_load_dwordx4 v[136:139], v2, s[32:35], s85 offen nt
  s_add_u32 s85, s85, 8192
  s_waitcnt vmcnt(5)
  v_dot2c_f32_bf16_dpp v16, v42, v124 row_newbcast:11 row_mask:0xf bank_mask:0xf
  v_dot2c_f32_bf16_dpp v17, v43, v124 row_newbcast:11 row_mask:0xf bank_mask:0xf
  v_dot2c_f32_bf16_dpp v18, v42, v125 row_newbcast:11 row_mask:0xf bank_mask:0xf
  v_dot2c_f32_bf16_dpp v19, v43, v125 row_newbcast:11 row_mask:0xf bank_mask:0xf
  v_dot2c_f32_bf16_dpp v20, v42, v126 row_newbcast:11 row_mask:0xf bank_mask:0xf
  v_dot2c_f32_bf16_dpp v21, v43, v126 row_newbcast:11 row_mask:0xf bank_mask:0xf
  v_dot2c_f32_bf16_dpp v22, v42, v127 row_newbcast:11 row_mask:0xf bank_mask:0xf
  v_dot2c_f32_bf16_dpp v23, v43, v127 row_newbcast:11 row_mask:0xf bank_mask:0xf
  buffer_load_dwordx4 v[140:143], v2, s[32:35], s85 offen nt
  s_add_u32 s85, s85, 8192
  s_waitcnt vmcnt(5)
  ds_write_b128 v4, v[224:227] offset:0
  ds_write_b128 v4, v[228:231] offset:1152
  ds_write_b128 v4, v[232:235] offset:2304
  ds_write_b128 v4, v[236:239] offset:3456
  ds_read_b64_tr_b16 v[224:225], v5 offset:0
  ds_read_b64_tr_b16 v[226:227], v5 offset:576
  ds_read_b64_tr_b16 v[228:229], v5 offset:32
  ds_read_b64_tr_b16 v[230:231], v5 offset:608
  ds_read_b64_tr_b16 v[232:233], v5 offset:64
  ds_read_b64_tr_b16 v[234:235], v5 offset:640
  ds_read_b64_tr_b16 v[236:237], v5 offset:96
  ds_read_b64_tr_b16 v[238:239], v5 offset:672
  buffer_load_dwordx4 v[244:247], v6, s[48:51], s83 offen nt
  s_add_u32 s83, s83, 8192
  s_cmp_lg_u32 s64, 0
  s_cbranch_scc1 L_skip8
  v_mov_b32 v11, 0
  s_mov_b32 s65, 0
L_ml_loop:
  ds_read_b32 v12, v11 offset:4480
  s_waitcnt lgkmcnt(0)
  v_readfirstlane_b32 s66, v12
  s_add_u32 s65, s65, 1
  s_cmp_ge_u32 s65, 200000
  s_cbranch_scc1 L_ml_ok
s_nop 0
  s_cmp_lg_u32 s66, 8
  s_cbranch_scc1 L_ml_loop
L_ml_ok:
  v_and_b32 v12, 7, v1
  v_lshlrev_b32 v12, 3, v12
  ds_read_b64 v[54:55], v12 offset:4352
  s_waitcnt lgkmcnt(0)
  v_mov_b32 v56, v54
s_nop 1
  v_max_f32_dpp v56, v56, v56 quad_perm:[1,0,3,2] row_mask:0xf bank_mask:0xf
s_nop 1
  v_max_f32_dpp v56, v56, v56 quad_perm:[2,3,0,1] row_mask:0xf bank_mask:0xf
s_nop 1
  v_max_f32_dpp v56, v56, v56 row_half_mirror row_mask:0xf bank_mask:0xf
  v_sub_f32 v54, v54, v56
  v_mul_f32 v54, 0x3fb8aa3b, v54
  v_exp_f32 v54, v54
s_nop 0
  v_mul_f32 v57, v55, v54
s_nop 1
  v_add_f32_dpp v57, v57, v57 quad_perm:[1,0,3,2] row_mask:0xf bank_mask:0xf
s_nop 1
  v_add_f32_dpp v57, v57, v57 quad_perm:[2,3,0,1] row_mask:0xf bank_mask:0xf
s_nop 1
  v_add_f32_dpp v57, v57, v57 row_half_mirror row_mask:0xf bank_mask:0xf
  v_mov_b32 v58, s27
  v_not_b32 v59, v58
  s_lshl_b32 s65, s67, 4
  s_add_u32 s65, s65, 524288
  s_mov_b64 exec, 1
  buffer_store_dwordx4 v[56:59], v11, s[56:59], s65 offen sc1
  s_mov_b64 exec, -1
L_skip8:
  s_waitcnt vmcnt(5)
  v_dot2c_f32_bf16_dpp v16, v42, v128 row_newbcast:12 row_mask:0xf bank_mask:0xf
  v_dot2c_f32_bf16_dpp v17, v43, v128 row_newbcast:12 row_mask:0xf bank_mask:0xf
  v_dot2c_f32_bf16_dpp v18, v42, v129 row_newbcast:12 row_mask:0xf bank_mask:0xf
  v_dot2c_f32_bf16_dpp v19, v43, v129 row_newbcast:12 row_mask:0xf bank_mask:0xf
  v_dot2c_f32_bf16_dpp v20, v42, v130 row_newbcast:12 row_mask:0xf bank_mask:0xf
  v_dot2c_f32_bf16_dpp v21, v43, v130 row_newbcast:12 row_mask:0xf bank_mask:0xf
  v_dot2c_f32_bf16_dpp v22, v42, v131 row_newbcast:12 row_mask:0xf bank_mask:0xf
  v_dot2c_f32_bf16_dpp v23, v43, v131 row_newbcast:12 row_mask:0xf bank_mask:0xf
  buffer_load_dwordx4 v[144:147], v2, s[32:35], s85 offen nt
  s_add_u32 s85, s85, 8192
  s_waitcnt vmcnt(5)
  v_dot2c_f32_bf16_dpp v16, v42, v132 row_newbcast:13 row_mask:0xf bank_mask:0xf
  v_dot2c_f32_bf16_dpp v17, v43, v132 row_newbcast:13 row_mask:0xf bank_mask:0xf
  v_dot2c_f32_bf16_dpp v18, v42, v133 row_newbcast:13 row_mask:0xf bank_mask:0xf
  v_dot2c_f32_bf16_dpp v19, v43, v133 row_newbcast:13 row_mask:0xf bank_mask:0xf
  v_dot2c_f32_bf16_dpp v20, v42, v134 row_newbcast:13 row_mask:0xf bank_mask:0xf
  v_dot2c_f32_bf16_dpp v21, v43, v134 row_newbcast:13 row_mask:0xf bank_mask:0xf
  v_dot2c_f32_bf16_dpp v22, v42, v135 row_newbcast:13 row_mask:0xf bank_mask:0xf
  v_dot2c_f32_bf16_dpp v23, v43, v135 row_newbcast:13 row_mask:0xf bank_mask:0xf
  buffer_load_dwordx4 v[148:151], v2, s[32:35], s85 offen nt
  s_add_u32 s85, s85, 8192
  s_waitcnt vmcnt(5)
  buffer_load_dwordx4 v[248:251], v6, s[48:51], s83 offen nt
  s_add_u32 s83, s83, 8192
  s_waitcnt vmcnt(5)
  v_dot2c_f32_bf16_dpp v16, v42, v136 row_newbcast:14 row_mask:0xf bank_mask:0xf
  v_dot2c_f32_bf16_dpp v17, v43, v136 row_newbcast:14 row_mask:0xf bank_mask:0xf
  v_dot2c_f32_bf16_dpp v18, v42, v137 row_newbcast:14 row_mask:0xf bank_mask:0xf
  v_dot2c_f32_bf16_dpp v19, v43, v137 row_newbcast:14 row_mask:0xf bank_mask:0xf
  v_dot2c_f32_bf16_dpp v20, v42, v138 row_newbcast:14 row_mask:0xf bank_mask:0xf
  v_dot2c_f32_bf16_dpp v21, v43, v138 row_newbcast:14 row_mask:0xf bank_mask:0xf
  v_dot2c_f32_bf16_dpp v22, v42, v139 row_newbcast:14 row_mask:0xf bank_mask:0xf
  v_dot2c_f32_bf16_dpp v23, v43, v139 row_newbcast:14 row_mask:0xf bank_mask:0xf
  buffer_load_dwordx4 v[152:155], v2, s[32:35], s85 offen nt
  s_add_u32 s85, s85, 8192
  s_waitcnt vmcnt(5)
  v_dot2c_f32_bf16_dpp v16, v42, v140 row_newbcast:15 row_mask:0xf bank_mask:0xf
  v_dot2c_f32_bf16_dpp v17, v43, v140 row_newbcast:15 row_mask:0xf bank_mask:0xf
  v_dot2c_f32_bf16_dpp v18, v42, v141 row_newbcast:15 row_mask:0xf bank_mask:0xf
  v_dot2c_f32_bf16_dpp v19, v43, v141 row_newbcast:15 row_mask:0xf bank_mask:0xf
  v_dot2c_f32_bf16_dpp v20, v42, v142 row_newbcast:15 row_mask:0xf bank_mask:0xf
  v_dot2c_f32_bf16_dpp v21, v43, v142 row_newbcast:15 row_mask:0xf bank_mask:0xf
  v_dot2c_f32_bf16_dpp v22, v42, v143 row_newbcast:15 row_mask:0xf bank_mask:0xf
  v_dot2c_f32_bf16_dpp v23, v43, v143 row_newbcast:15 row_mask:0xf bank_mask:0xf
  buffer_load_dwordx4 v[156:159], v2, s[32:35], s85 offen nt
  s_add_u32 s85, s85, 8192
  s_waitcnt vmcnt(5)
  buffer_load_dwordx4 v[252:255], v6, s[48:51], s83 offen nt
  s_add_u32 s83, s83, 8192
  s_waitcnt vmcnt(5)
  v_dot2c_f32_bf16_dpp v16, v44, v144 row_newbcast:0 row_mask:0xf bank_mask:0xf
  v_dot2c_f32_bf16_dpp v17, v45, v144 row_newbcast:0 row_mask:0xf bank_mask:0xf
  v_dot2c_f32_bf16_dpp v18, v44, v145 row_newbcast:0 row_mask:0xf bank_mask:0xf
  v_dot2c_f32_bf16_dpp v19, v45, v145 row_newbcast:0 row_mask:0xf bank_mask:0xf
  v_dot2c_f32_bf16_dpp v20, v44, v146 row_newbcast:0 row_mask:0xf bank_mask:0xf
  v_dot2c_f32_bf16_dpp v21, v45, v146 row_newbcast:0 row_mask:0xf bank_mask:0xf
  v_dot2c_f32_bf16_dpp v22, v44, v147 row_newbcast:0 row_mask:0xf bank_mask:0xf
  v_dot2c_f32_bf16_dpp v23, v45, v147 row_newbcast:0 row_mask:0xf bank_mask:0xf
  buffer_load_dwordx4 v[160:163], v2, s[32:35], s85 offen nt
  s_add_u32 s85, s85, 8192
  s_waitcnt vmcnt(5)
  v_dot2c_f32_bf16_dpp v16, v44, v148 row_newbcast:1 row_mask:0xf bank_mask:0xf
  v_dot2c_f32_bf16_dpp v17, v45, v148 row_newbcast:1 row_mask:0xf bank_mask:0xf
  v_dot2c_f32_bf16_dpp v18, v44, v149 row_newbcast:1 row_mask:0xf bank_mask:0xf
  v_dot2c_f32_bf16_dpp v19, v45, v149 row_newbcast:1 row_mask:0xf bank_mask:0xf
  v_dot2c_f32_bf16_dpp v20, v44, v150 row_newbcast:1 row_mask:0xf bank_mask:0xf
  v_dot2c_f32_bf16_dpp v21, v45, v150 row_newbcast:1 row_mask:0xf bank_mask:0xf
  v_dot2c_f32_bf16_dpp v22, v44, v151 row_newbcast:1 row_mask:0xf bank_mask:0xf
  v_dot2c_f32_bf16_dpp v23, v45, v151 row_newbcast:1 row_mask:0xf bank_mask:0xf
  buffer_load_dwordx4 v[164:167], v2, s[32:35], s85 offen nt
  s_add_u32 s85, s85, 8192
  s_waitcnt vmcnt(5)
  buffer_load_dwordx4 v[64:67], v6, s[48:51], s83 offen nt
  s_add_u32 s83, s83, 8192
  s_waitcnt vmcnt(5)
  v_dot2c_f32_bf16_dpp v16, v44, v152 row_newbcast:2 row_mask:0xf bank_mask:0xf
  v_dot2c_f32_bf16_dpp v17, v45, v152 row_newbcast:2 row_mask:0xf bank_mask:0xf
  v_dot2c_f32_bf16_dpp v18, v44, v153 row_newbcast:2 row_mask:0xf bank_mask:0xf
  v_dot2c_f32_bf16_dpp v19, v45, v153 row_newbcast:2 row_mask:0xf bank_mask:0xf
  v_dot2c_f32_bf16_dpp v20, v44, v154 row_newbcast:2 row_mask:0xf bank_mask:0xf
  v_dot2c_f32_bf16_dpp v21, v45, v154 row_newbcast:2 row_mask:0xf bank_mask:0xf
  v_dot2c_f32_bf16_dpp v22, v44, v155 row_newbcast:2 row_mask:0xf bank_mask:0xf
  v_dot2c_f32_bf16_dpp v23, v45, v155 row_newbcast:2 row_mask:0xf bank_mask:0xf
  buffer_load_dwordx4 v[168:171], v2, s[32:35], s85 offen nt
  s_add_u32 s85, s85, 8192
  s_waitcnt vmcnt(5)
  v_dot2c_f32_bf16_dpp v16, v44, v156 row_newbcast:3 row_mask:0xf bank_mask:0xf
  v_dot2c_f32_bf16_dpp v17, v45, v156 row_newbcast:3 row_mask:0xf bank_mask:0xf
  v_dot2c_f32_bf16_dpp v18, v44, v157 row_newbcast:3 row_mask:0xf bank_mask:0xf
  v_dot2c_f32_bf16_dpp v19, v45, v157 row_newbcast:3 row_mask:0xf bank_mask:0xf
  v_dot2c_f32_bf16_dpp v20, v44, v158 row_newbcast:3 row_mask:0xf bank_mask:0xf
  v_dot2c_f32_bf16_dpp v21, v45, v158 row_newbcast:3 row_mask:0xf bank_mask:0xf
  v_dot2c_f32_bf16_dpp v22, v44, v159 row_newbcast:3 row_mask:0xf bank_mask:0xf
  v_dot2c_f32_bf16_dpp v23, v45, v159 row_newbcast:3 row_mask:0xf bank_mask:0xf
  buffer_load_dwordx4 v[172:175], v2, s[32:35], s85 offen nt
  s_add_u32 s85, s85, 8192
  s_waitcnt vmcnt(5)
  ds_write_b128 v4, v[240:243] offset:0
  ds_write_b128 v4, v[244:247] offset:1152
  ds_write_b128 v4, v[248:251] offset:2304
  ds_write_b128 v4, v[252:255] offset:3456
  ds_read_b64_tr_b16 v[240:241], v5 offset:0
  ds_read_b64_tr_b16 v[242:243], v5 offset:576
  ds_read_b64_tr_b16 v[244:245], v5 offset:32
  ds_read_b64_tr_b16 v[246:247], v5 offset:608
  ds_read_b64_tr_b16 v[248:249], v5 offset:64
  ds_read_b64_tr_b16 v[250:251], v5 offset:640
  ds_read_b64_tr_b16 v[252:253], v5 offset:96
  ds_read_b64_tr_b16 v[254:255], v5 offset:672
  buffer_load_dwordx4 v[68:71], v6, s[48:51], s83 offen nt
  s_add_u32 s83, s83, 8192
  s_waitcnt vmcnt(5)
  v_dot2c_f32_bf16_dpp v16, v44, v160 row_newbcast:4 row_mask:0xf bank_mask:0xf
  v_dot2c_f32_bf16_dpp v17, v45, v160 row_newbcast:4 row_mask:0xf bank_mask:0xf
  v_dot2c_f32_bf16_dpp v18, v44, v161 row_newbcast:4 row_mask:0xf bank_mask:0xf
  v_dot2c_f32_bf16_dpp v19, v45, v161 row_newbcast:4 row_mask:0xf bank_mask:0xf
  v_dot2c_f32_bf16_dpp v20, v44, v162 row_newbcast:4 row_mask:0xf bank_mask:0xf
  v_dot2c_f32_bf16_dpp v21, v45, v162 row_newbcast:4 row_mask:0xf bank_mask:0xf
  v_dot2c_f32_bf16_dpp v22, v44, v163 row_newbcast:4 row_mask:0xf bank_mask:0xf
  v_dot2c_f32_bf16_dpp v23, v45, v163 row_newbcast:4 row_mask:0xf bank_mask:0xf
  buffer_load_dwordx4 v[176:179], v2, s[32:35], s85 offen nt
  s_add_u32 s85, s85, 8192
  s_waitcnt vmcnt(5)
  v_dot2c_f32_bf16_dpp v16, v44, v164 row_newbcast:5 row_mask:0xf bank_mask:0xf
  v_dot2c_f32_bf16_dpp v17, v45, v164 row_newbcast:5 row_mask:0xf bank_mask:0xf
  v_dot2c_f32_bf16_dpp v18, v44, v165 row_newbcast:5 row_mask:0xf bank_mask:0xf
  v_dot2c_f32_bf16_dpp v19, v45, v165 row_newbcast:5 row_mask:0xf bank_mask:0xf
  v_dot2c_f32_bf16_dpp v20, v44, v166 row_newbcast:5 row_mask:0xf bank_mask:0xf
  v_dot2c_f32_bf16_dpp v21, v45, v166 row_newbcast:5 row_mask:0xf bank_mask:0xf
  v_dot2c_f32_bf16_dpp v22, v44, v167 row_newbcast:5 row_mask:0xf bank_mask:0xf
  v_dot2c_f32_bf16_dpp v23, v45, v167 row_newbcast:5 row_mask:0xf bank_mask:0xf
  buffer_load_dwordx4 v[180:183], v2, s[32:35], s85 offen nt
  s_add_u32 s85, s85, 8192
  s_waitcnt vmcnt(5)
  buffer_load_dwordx4 v[72:75], v6, s[48:51], s83 offen nt
  s_add_u32 s83, s83, 8192
  s_waitcnt vmcnt(5)
  v_dot2c_f32_bf16_dpp v16, v44, v168 row_newbcast:6 row_mask:0xf bank_mask:0xf
  v_dot2c_f32_bf16_dpp v17, v45, v168 row_newbcast:6 row_mask:0xf bank_mask:0xf
  v_dot2c_f32_bf16_dpp v18, v44, v169 row_newbcast:6 row_mask:0xf bank_mask:0xf
  v_dot2c_f32_bf16_dpp v19, v45, v169 row_newbcast:6 row_mask:0xf bank_mask:0xf
  v_dot2c_f32_bf16_dpp v20, v44, v170 row_newbcast:6 row_mask:0xf bank_mask:0xf
  v_dot2c_f32_bf16_dpp v21, v45, v170 row_newbcast:6 row_mask:0xf bank_mask:0xf
  v_dot2c_f32_bf16_dpp v22, v44, v171 row_newbcast:6 row_mask:0xf bank_mask:0xf
  v_dot2c_f32_bf16_dpp v23, v45, v171 row_newbcast:6 row_mask:0xf bank_mask:0xf
  buffer_load_dwordx4 v[184:187], v2, s[32:35], s85 offen nt
  s_add_u32 s85, s85, 8192
  s_waitcnt vmcnt(5)
  v_dot2c_f32_bf16_dpp v16, v44, v172 row_newbcast:7 row_mask:0xf bank_mask:0xf
  v_dot2c_f32_bf16_dpp v17, v45, v172 row_newbcast:7 row_mask:0xf bank_mask:0xf
  v_dot2c_f32_bf16_dpp v18, v44, v173 row_newbcast:7 row_mask:0xf bank_mask:0xf
  v_dot2c_f32_bf16_dpp v19, v45, v173 row_newbcast:7 row_mask:0xf bank_mask:0xf
  v_dot2c_f32_bf16_dpp v20, v44, v174 row_newbcast:7 row_mask:0xf bank_mask:0xf
  v_dot2c_f32_bf16_dpp v21, v45, v174 row_newbcast:7 row_mask:0xf bank_mask:0xf
  v_dot2c_f32_bf16_dpp v22, v44, v175 row_newbcast:7 row_mask:0xf bank_mask:0xf
  v_dot2c_f32_bf16_dpp v23, v45, v175 row_newbcast:7 row_mask:0xf bank_mask:0xf
  buffer_load_dwordx4 v[188:191], v2, s[32:35], s85 offen nt
  s_add_u32 s85, s85, 8192
  s_waitcnt vmcnt(5)
  buffer_load_dwordx4 v[76:79], v6, s[48:51], s83 offen nt
  s_xor_b32 s65, s67, 1
  s_lshl_b32 s65, s65, 4
  s_add_u32 s26, s65, 524288
  v_mov_b32 v11, 0
  s_cmp_lg_u32 s64, 0
  s_cbranch_scc1 L_skip9
  buffer_load_dwordx4 v[60:63], v11, s[56:59], s26 offen sc1
L_skip9:
  s_waitcnt vmcnt(5)
  v_dot2c_f32_bf16_dpp v16, v44, v176 row_newbcast:8 row_mask:0xf bank_mask:0xf
  v_dot2c_f32_bf16_dpp v17, v45, v176 row_newbcast:8 row_mask:0xf bank_mask:0xf
  v_dot2c_f32_bf16_dpp v18, v44, v177 row_newbcast:8 row_mask:0xf bank_mask:0xf
  v_dot2c_f32_bf16_dpp v19, v45, v177 row_newbcast:8 row_mask:0xf bank_mask:0xf
  v_dot2c_f32_bf16_dpp v20, v44, v178 row_newbcast:8 row_mask:0xf bank_mask:0xf
  v_dot2c_f32_bf16_dpp v21, v45, v178 row_newbcast:8 row_mask:0xf bank_mask:0xf
  v_dot2c_f32_bf16_dpp v22, v44, v179 row_newbcast:8 row_mask:0xf bank_mask:0xf
  v_dot2c_f32_bf16_dpp v23, v45, v179 row_newbcast:8 row_mask:0xf bank_mask:0xf
  buffer_load_dwordx4 v[192:195], v2, s[32:35], s85 offen nt
  s_add_u32 s85, s85, 8192
  s_waitcnt vmcnt(5)
  v_dot2c_f32_bf16_dpp v16, v44, v180 row_newbcast:9 row_mask:0xf bank_mask:0xf
  v_dot2c_f32_bf16_dpp v17, v45, v180 row_newbcast:9 row_mask:0xf bank_mask:0xf
  v_dot2c_f32_bf16_dpp v18, v44, v181 row_newbcast:9 row_mask:0xf bank_mask:0xf
  v_dot2c_f32_bf16_dpp v19, v45, v181 row_newbcast:9 row_mask:0xf bank_mask:0xf
  v_dot2c_f32_bf16_dpp v20, v44, v182 row_newbcast:9 row_mask:0xf bank_mask:0xf
  v_dot2c_f32_bf16_dpp v21, v45, v182 row_newbcast:9 row_mask:0xf bank_mask:0xf
  v_dot2c_f32_bf16_dpp v22, v44, v183 row_newbcast:9 row_mask:0xf bank_mask:0xf
  v_dot2c_f32_bf16_dpp v23, v45, v183 row_newbcast:9 row_mask:0xf bank_mask:0xf
  buffer_load_dwordx4 v[196:199], v2, s[32:35], s85 offen nt
  s_add_u32 s85, s85, 8192
  s_waitcnt vmcnt(5)
  buffer_load_dwordx4 v[200:203], v2, s[32:35], s85 offen nt
  s_add_u32 s85, s85, 8192
  s_waitcnt vmcnt(5)
  v_dot2c_f32_bf16_dpp v16, v44, v184 row_newbcast:10 row_mask:0xf bank_mask:0xf
  v_dot2c_f32_bf16_dpp v17, v45, v184 row_newbcast:10 row_mask:0xf bank_mask:0xf
  v_dot2c_f32_bf16_dpp v18, v44, v185 row_newbcast:10 row_mask:0xf bank_mask:0xf
  v_dot2c_f32_bf16_dpp v19, v45, v185 row_newbcast:10 row_mask:0xf bank_mask:0xf
  v_dot2c_f32_bf16_dpp v20, v44, v186 row_newbcast:10 row_mask:0xf bank_mask:0xf
  v_dot2c_f32_bf16_dpp v21, v45, v186 row_newbcast:10 row_mask:0xf bank_mask:0xf
  v_dot2c_f32_bf16_dpp v22, v44, v187 row_newbcast:10 row_mask:0xf bank_mask:0xf
  v_dot2c_f32_bf16_dpp v23, v45, v187 row_newbcast:10 row_mask:0xf bank_mask:0xf
  buffer_load_dwordx4 v[204:207], v2, s[32:35], s85 offen nt
  s_waitcnt vmcnt(5)
  v_dot2c_f32_bf16_dpp v16, v44, v188 row_newbcast:11 row_mask:0xf bank_mask:0xf
  v_dot2c_f32_bf16_dpp v17, v45, v188 row_newbcast:11 row_mask:0xf bank_mask:0xf
  v_dot2c_f32_bf16_dpp v18, v44, v189 row_newbcast:11 row_mask:0xf bank_mask:0xf
  v_dot2c_f32_bf16_dpp v19, v45, v189 row_newbcast:11 row_mask:0xf bank_mask:0xf
  v_dot2c_f32_bf16_dpp v20, v44, v190 row_newbcast:11 row_mask:0xf bank_mask:0xf
  v_dot2c_f32_bf16_dpp v21, v45, v190 row_newbcast:11 row_mask:0xf bank_mask:0xf
  v_dot2c_f32_bf16_dpp v22, v44, v191 row_newbcast:11 row_mask:0xf bank_mask:0xf
  v_dot2c_f32_bf16_dpp v23, v45, v191 row_newbcast:11 row_mask:0xf bank_mask:0xf
  s_waitcnt vmcnt(4)
  ds_write_b128 v4, v[64:67] offset:0
  ds_write_b128 v4, v[68:71] offset:1152
  ds_write_b128 v4, v[72:75] offset:2304
  ds_write_b128 v4, v[76:79] offset:3456
  ds_read_b64_tr_b16 v[64:65], v5 offset:0
  ds_read_b64_tr_b16 v[66:67], v5 offset:576
  ds_read_b64_tr_b16 v[68:69], v5 offset:32
  ds_read_b64_tr_b16 v[70:71], v5 offset:608
  ds_read_b64_tr_b16 v[72:73], v5 offset:64
  ds_read_b64_tr_b16 v[74:75], v5 offset:640
  ds_read_b64_tr_b16 v[76:77], v5 offset:96
  ds_read_b64_tr_b16 v[78:79], v5 offset:672
  s_waitcnt vmcnt(3)
  v_dot2c_f32_bf16_dpp v16, v44, v192 row_newbcast:12 row_mask:0xf bank_mask:0xf
  v_dot2c_f32_bf16_dpp v17, v45, v192 row_newbcast:12 row_mask:0xf bank_mask:0xf
  v_dot2c_f32_bf16_dpp v18, v44, v193 row_newbcast:12 row_mask:0xf bank_mask:0xf
  v_dot2c_f32_bf16_dpp v19, v45, v193 row_newbcast:12 row_mask:0xf bank_mask:0xf
  v_dot2c_f32_bf16_dpp v20, v44, v194 row_newbcast:12 row_mask:0xf bank_mask:0xf
  v_dot2c_f32_bf16_dpp v21, v45, v194 row_newbcast:12 row_mask:0xf bank_mask:0xf
  v_dot2c_f32_bf16_dpp v22, v44, v195 row_newbcast:12 row_mask:0xf bank_mask:0xf
  v_dot2c_f32_bf16_dpp v23, v45, v195 row_newbcast:12 row_mask:0xf bank_mask:0xf
  s_waitcnt vmcnt(2)
  v_dot2c_f32_bf16_dpp v16, v44, v196 row_newbcast:13 row_mask:0xf bank_mask:0xf
  v_dot2c_f32_bf16_dpp v17, v45, v196 row_newbcast:13 row_mask:0xf bank_mask:0xf
  v_dot2c_f32_bf16_dpp v18, v44, v197 row_newbcast:13 row_mask:0xf bank_mask:0xf
  v_dot2c_f32_bf16_dpp v19, v45, v197 row_newbcast:13 row_mask:0xf bank_mask:0xf
  v_dot2c_f32_bf16_dpp v20, v44, v198 row_newbcast:13 row_mask:0xf bank_mask:0xf
  v_dot2c_f32_bf16_dpp v21, v45, v198 row_newbcast:13 row_mask:0xf bank_mask:0xf
  v_dot2c_f32_bf16_dpp v22, v44, v199 row_newbcast:13 row_mask:0xf bank_mask:0xf
  v_dot2c_f32_bf16_dpp v23, v45, v199 row_newbcast:13 row_mask:0xf bank_mask:0xf
  s_waitcnt vmcnt(1)
  v_dot2c_f32_bf16_dpp v16, v44, v200 row_newbcast:14 row_mask:0xf bank_mask:0xf
  v_dot2c_f32_bf16_dpp v17, v45, v200 row_newbcast:14 row_mask:0xf bank_mask:0xf
  v_dot2c_f32_bf16_dpp v18, v44, v201 row_newbcast:14 row_mask:0xf bank_mask:0xf
  v_dot2c_f32_bf16_dpp v19, v45, v201 row_newbcast:14 row_mask:0xf bank_mask:0xf
  v_dot2c_f32_bf16_dpp v20, v44, v202 row_newbcast:14 row_mask:0xf bank_mask:0xf
  v_dot2c_f32_bf16_dpp v21, v45, v202 row_newbcast:14 row_mask:0xf bank_mask:0xf
  v_dot2c_f32_bf16_dpp v22, v44, v203 row_newbcast:14 row_mask:0xf bank_mask:0xf
  v_dot2c_f32_bf16_dpp v23, v45, v203 row_newbcast:14 row_mask:0xf bank_mask:0xf
  s_waitcnt vmcnt(0)
  v_dot2c_f32_bf16_dpp v16, v44, v204 row_newbcast:15 row_mask:0xf bank_mask:0xf
  v_dot2c_f32_bf16_dpp v17, v45, v204 row_newbcast:15 row_mask:0xf bank_mask:0xf
  v_dot2c_f32_bf16_dpp v18, v44, v205 row_newbcast:15 row_mask:0xf bank_mask:0xf
  v_dot2c_f32_bf16_dpp v19, v45, v205 row_newbcast:15 row_mask:0xf bank_mask:0xf
  v_dot2c_f32_bf16_dpp v20, v44, v206 row_newbcast:15 row_mask:0xf bank_mask:0xf
  v_dot2c_f32_bf16_dpp v21, v45, v206 row_newbcast:15 row_mask:0xf bank_mask:0xf
  v_dot2c_f32_bf16_dpp v22, v44, v207 row_newbcast:15 row_mask:0xf bank_mask:0xf
  v_dot2c_f32_bf16_dpp v23, v45, v207 row_newbcast:15 row_mask:0xf bank_mask:0xf
  v_permlane32_swap_b32 v16, v20
  v_permlane32_swap_b32 v17, v21
  v_permlane32_swap_b32 v18, v22
  v_permlane32_swap_b32 v19, v23
  v_add_f32 v16, v16, v20
  v_add_f32 v17, v17, v21
  v_add_f32 v18, v18, v22
  v_add_f32 v19, v19, v23
s_nop 0
  v_permlane16_swap_b32 v16, v18
  v_permlane16_swap_b32 v17, v19
  v_add_f32 v16, v16, v18
  v_add_f32 v17, v17, v19
  v_cvt_pk_bf16_f32 v16, v16, v17
  ds_write_b32 v14, v16 offset:4608
  v_mul_u32_u24 v12, 272, v10
  v_lshl_add_u32 v12, v9, 4, v12
  s_cmp_lg_u32 s64, 0
  s_cbranch_scc1 L_skip10
  s_waitcnt vmcnt(4)
  v_readfirstlane_b32 s65, v62
s_nop 3
  s_cmp_eq_u32 s65, s27
  s_cbranch_scc1 L_pm_ok
  s_mov_b32 s66, 0
L_pm_loop:
  buffer_load_dwordx4 v[60:63], v11, s[56:59], s26 offen sc1
  s_waitcnt vmcnt(0)
  v_readfirstlane_b32 s65, v62
  s_add_u32 s66, s66, 1
  s_cmp_ge_u32 s66, 200000
  s_cbranch_scc1 L_pm_ok
s_nop 0
  s_cmp_lg_u32 s65, s27
  s_cbranch_scc1 L_pm_loop
L_pm_ok:
  ds_write_b64 v11, v[60:61] offset:4416
L_skip10:
  s_waitcnt lgkmcnt(0)
  s_barrier
  ds_read_b64 v[56:57], v15 offset:4352
  ds_read_b128 v[80:83], v12 offset:4608
  ds_read_b128 v[84:87], v12 offset:4672
  ds_read_b128 v[88:91], v12 offset:4736
  ds_read_b128 v[92:95], v12 offset:4800
  v_lshrrev_b32 v11, 2, v1
  v_lshl_add_u32 v11, v7, 4, v11
  v_lshrrev_b32 v14, 1, v11
  v_lshlrev_b32 v14, 11, v14
  v_and_b32 v11, 1, v11
  v_lshl_add_u32 v14, v11, 4, v14
  s_lshl_b32 s87, s60, 17
  s_lshl_b32 s66, s63, 5
  s_add_u32 s87, s87, s66
  s_waitcnt lgkmcnt(0)
  v_mfma_f32_16x16x32_bf16 v[24:27], v[80:83], v[208:211], v[24:27]
  v_mov_b32 v58, v56
s_nop 1
  v_max_f32_dpp v58, v58, v58 quad_perm:[1,0,3,2] row_mask:0xf bank_mask:0xf
  v_mfma_f32_16x16x32_bf16 v[28:31], v[80:83], v[212:215], v[28:31]
s_nop 0
  v_max_f32_dpp v58, v58, v58 quad_perm:[2,3,0,1] row_mask:0xf bank_mask:0xf
s_nop 1
  v_max_f32_dpp v58, v58, v58 row_half_mirror row_mask:0xf bank_mask:0xf
  v_mfma_f32_16x16x32_bf16 v[32:35], v[80:83], v[216:219], v[32:35]
s_nop 0
  v_max_f32_dpp v58, v58, v58 row_mirror row_mask:0xf bank_mask:0xf
  v_sub_f32 v56, v56, v58
  v_mfma_f32_16x16x32_bf16 v[36:39], v[80:83], v[220:223], v[36:39]
  v_mul_f32 v56, 0x3fb8aa3b, v56
  v_exp_f32 v56, v56
  v_mfma_f32_16x16x32_bf16 v[24:27], v[84:87], v[224:227], v[24:27]
  v_mul_f32 v57, v57, v56
s_nop 1
  v_add_f32_dpp v57, v57, v57 quad_perm:[1,0,3,2] row_mask:0xf bank_mask:0xf
  v_mfma_f32_16x16x32_bf16 v[28:31], v[84:87], v[228:231], v[28:31]
s_nop 0
  v_add_f32_dpp v57, v57, v57 quad_perm:[2,3,0,1] row_mask:0xf bank_mask:0xf
s_nop 1
  v_add_f32_dpp v57, v57, v57 row_half_mirror row_mask:0xf bank_mask:0xf
  v_mfma_f32_16x16x32_bf16 v[32:35], v[84:87], v[232:235], v[32:35]
s_nop 0
  v_add_f32_dpp v57, v57, v57 row_mirror row_mask:0xf bank_mask:0xf
  v_rcp_f32 v57, v57
  v_mfma_f32_16x16x32_bf16 v[36:39], v[84:87], v[236:239], v[36:39]
  v_cmp_gt_u32 s[70:71], 8, v10
  v_cmp_eq_u32 s[72:73], 8, v10
  v_mfma_f32_16x16x32_bf16 v[24:27], v[88:91], v[240:243], v[24:27]
  v_mul_f32 v56, v56, v57
  v_cndmask_b32 v56, 0, v56, s[70:71]
  v_mfma_f32_16x16x32_bf16 v[28:31], v[88:91], v[244:247], v[28:31]
  v_cndmask_b32 v56, v56, 1.0, s[72:73]
  v_lshlrev_b32 v11, 2, v10
  v_mfma_f32_16x16x32_bf16 v[32:35], v[88:91], v[248:251], v[32:35]
  ds_write_b32 v11, v56 offset:10240
  v_lshlrev_b32 v11, 4, v9
  v_mfma_f32_16x16x32_bf16 v[36:39], v[88:91], v[252:255], v[36:39]
  ds_read_b128 v[48:51], v11 offset:10240
  v_mfma_f32_16x16x32_bf16 v[24:27], v[92:95], v[64:67], v[24:27]
  v_mfma_f32_16x16x32_bf16 v[28:31], v[92:95], v[68:71], v[28:31]
  v_mfma_f32_16x16x32_bf16 v[32:35], v[92:95], v[72:75], v[32:35]
  v_mfma_f32_16x16x32_bf16 v[36:39], v[92:95], v[76:79], v[36:39]
  s_waitcnt lgkmcnt(0)
s_nop 3
  v_mul_f32 v52, v48, v24
  v_fmac_f32 v52, v49, v25
  v_fmac_f32 v52, v50, v26
  v_fmac_f32 v52, v51, v27
  v_mul_f32 v53, v48, v28
  v_fmac_f32 v53, v49, v29
  v_fmac_f32 v53, v50, v30
  v_fmac_f32 v53, v51, v31
  v_mul_f32 v54, v48, v32
  v_fmac_f32 v54, v49, v33
  v_fmac_f32 v54, v50, v34
  v_fmac_f32 v54, v51, v35
  v_mul_f32 v55, v48, v36
  v_fmac_f32 v55, v49, v37
  v_fmac_f32 v55, v50, v38
  v_fmac_f32 v55, v51, v39
  v_permlane32_swap_b32 v52, v54
s_nop 0
  v_permlane32_swap_b32 v53, v55
  v_add_f32 v52, v52, v54
  v_add_f32 v53, v53, v55
s_nop 1
  v_permlane16_swap_b32 v52, v53
  v_add_f32 v52, v52, v53
s_nop 1
  v_mov_b32_dpp v53, v52 quad_perm:[1,1,1,1] row_mask:0xf bank_mask:0xf
  v_mov_b32_dpp v54, v52 quad_perm:[2,2,2,2] row_mask:0xf bank_mask:0xf
  v_mov_b32_dpp v55, v52 quad_perm:[3,3,3,3] row_mask:0xf bank_mask:0xf
  v_perm_b32 v56, v52, v47, s92
  v_perm_b32 v57, v53, v47, s93
  v_perm_b32 v58, v54, v47, s94
  v_perm_b32 v59, v55, v47, s95
  s_mov_b32 exec_lo, 0x11111111
  s_mov_b32 exec_hi, 0x11111111
  buffer_store_dwordx4 v[56:59], v14, s[56:59], s87 offen sc1
  s_mov_b64 exec, -1
  s_cmp_lg_u32 s64, 0
  s_cbranch_scc1 L_fin_skip
  s_lshl_b32 s65, s67, 11
  s_mov_b64 s[66:67], -1
  s_mov_b64 s[68:69], -1
  s_mov_b32 s26, 0
L_fin_loop:
  s_mov_b64 exec, s[66:67]
  buffer_load_dwordx4 v[48:51], v8, s[56:59], s65 offen sc1
  s_mov_b64 exec, s[68:69]
  buffer_load_dwordx4 v[52:55], v8, s[56:59], s65 offen offset:1024 sc1
  s_mov_b64 exec, -1
  s_waitcnt vmcnt(0)
  v_perm_b32 v56, v49, v48, s96
  v_perm_b32 v57, v51, v50, s97
  v_or_b32 v56, v56, v57
  v_perm_b32 v58, v53, v52, s96
  v_perm_b32 v59, v55, v54, s97
  v_or_b32 v58, v58, v59
  v_cmp_ne_u32 s[66:67], v56, v47
  v_cmp_ne_u32 s[68:69], v58, v47
s_nop 3
  s_or_b64 s[90:91], s[66:67], s[68:69]
  s_cbranch_scc0 L_fin_done
  s_add_u32 s26, s26, 1
  s_cmp_lt_u32 s26, 200000
  s_cbranch_scc1 L_fin_loop
L_fin_done:
  v_mov_b32 v12, 0x80
  v_perm_b32 v48, v48, v12, s92
  v_perm_b32 v49, v49, v12, s92
  v_perm_b32 v50, v50, v12, s92
  v_perm_b32 v51, v51, v12, s92
  v_perm_b32 v52, v52, v12, s92
  v_perm_b32 v53, v53, v12, s92
  v_perm_b32 v54, v54, v12, s92
  v_perm_b32 v55, v55, v12, s92
  v_add_f32 v48, v48, v52
  v_add_f32 v49, v49, v53
  v_add_f32 v50, v50, v54
  v_add_f32 v51, v51, v55
s_nop 0
  v_permlane32_swap_b32 v48, v50
  v_permlane32_swap_b32 v49, v51
  v_add_f32 v48, v48, v50
  v_add_f32 v49, v49, v51
s_nop 1
  v_permlane16_swap_b32 v48, v49
  v_add_f32 v48, v48, v49
s_nop 1
  v_add_f32_dpp v48, v48, v48 quad_perm:[2,3,0,1] row_mask:0xf bank_mask:0xf
s_nop 1
  v_add_f32_dpp v48, v48, v48 row_ror:4 row_mask:0xf bank_mask:0xf
s_nop 1
  v_add_f32_dpp v48, v48, v48 row_ror:8 row_mask:0xf bank_mask:0xf
  v_lshlrev_b32 v46, 16, v46
  v_add_f32 v48, v48, v46
  v_cvt_pk_bf16_f32 v48, v48, v48
  v_and_b32 v11, 1, v10
  v_lshl_add_u32 v11, v11, 2, v9
  s_lshl_b32 s65, s63, 3
  s_lshl_b32 s66, s60, 9
  s_add_u32 s65, s65, s66
  v_add_u32 v11, s65, v11
  v_lshlrev_b32 v11, 1, v11
  s_mov_b32 s66, 0x00030003
  s_mov_b32 exec_lo, s66
  s_mov_b32 exec_hi, s66
  global_store_short v11, v48, s[20:21]
  s_mov_b64 exec, -1
L_fin_skip:
L_main_end:
  s_endpgm
.section .rodata,"a"
.p2align 6
.amdhsa_kernel parallel_sum__sliding_block_cached__dense_activation_silu__decode_kernel
  .amdhsa_next_free_vgpr 256
  .amdhsa_next_free_sgpr 102
  .amdhsa_accum_offset 256
  .amdhsa_group_segment_fixed_size 0
  .amdhsa_kernarg_size 88
  .amdhsa_user_sgpr_count 2
  .amdhsa_user_sgpr_kernarg_segment_ptr 1
  .amdhsa_system_sgpr_workgroup_id_x 1
  .amdhsa_float_denorm_mode_32 3
.end_amdhsa_kernel
```
